```python
import torch

def _softmax(x, axis=-1):
    return torch.softmax(x, dim=axis)
def _gelu(x):
    return torch.nn.functional.gelu(x, approximate="tanh")
def _silu(x):
    return torch.nn.functional.silu(x)
def _sigmoid(x):
    return torch.sigmoid(x)
def _layernorm(x, axis=-1, eps=1e-5):
    m = x.mean(dim=axis, keepdim=True)
    v = x.var(dim=axis, keepdim=True, unbiased=False)
    return (x - m) / torch.sqrt(v + eps)
def _scatter_add(tgt, idx, src, axis=0):
    return tgt.clone().index_add_(axis, idx, src)
def _segment_sum(src, seg, n):
    out = torch.zeros((n,) + src.shape[1:], dtype=src.dtype)
    return out.index_add_(0, seg, src)
def _pad(x, pw):
    flat = tuple(v for pair in reversed(pw) for v in pair)
    return torch.nn.functional.pad(x, flat)

kernel_name = 'gated_mix__spectral_fnet__grouped_kv_mqa__prompt'

def setup_inputs():

    _w = (lambda a: (lambda t: t.to(torch.bfloat16) if t.is_floating_point() else t)(torch.as_tensor(a)))
    def _A_setup():
        B, S, D = 1, 2048, 576
        ns = torch.arange(S)[:, None] * torch.arange(S)[None, :]
        nd = torch.arange(D)[:, None] * torch.arange(D)[None, :]
        Ws_re = torch.cos(-2.0 * torch.pi * ns / S).to(float)
        Ws_im = torch.sin(-2.0 * torch.pi * ns / S).to(float)
        Wd_re = torch.cos(-2.0 * torch.pi * nd / D).to(float)
        Wd_im = torch.sin(-2.0 * torch.pi * nd / D).to(float)
        return {
            "x": _w((lambda *s: torch.randn(*s, dtype=torch.bfloat16) * 0.05)(B, S, D)),
            "dft_seq_re": _w(Ws_re),
            "dft_seq_im": _w(Ws_im),
            "dft_hid_re": _w(Wd_re),
            "dft_hid_im": _w(Wd_im),
        }
    _A_in = _A_setup()

    def _B_setup():
        B, S, D, H = 1, 2048, 576, 32
        Dh = D // H
        return {
            "x": _w((lambda *s: torch.randn(*s, dtype=torch.bfloat16) * 0.05)(B, S, D)),
            "wq": _w((lambda *s: torch.randn(*s, dtype=torch.bfloat16) * 3.2)(D, H * Dh)),
            "wk": _w((lambda *s: torch.randn(*s, dtype=torch.bfloat16) * 3.2)(D, Dh)),
            "wv": _w((lambda *s: torch.randn(*s, dtype=torch.bfloat16) * 0.4)(D, Dh)),
            "wo": _w((lambda *s: torch.randn(*s, dtype=torch.bfloat16) * 0.4)(H * Dh, D)),
        }
    _B_in = _B_setup()

    return {
        "A_x": _A_in["x"],
        "A_dft_seq_re": _A_in["dft_seq_re"],
        "A_dft_seq_im": _A_in["dft_seq_im"],
        "A_dft_hid_re": _A_in["dft_hid_re"],
        "A_dft_hid_im": _A_in["dft_hid_im"],
        "B_x": _B_in["x"],
        "B_wq": _B_in["wq"],
        "B_wk": _B_in["wk"],
        "B_wv": _B_in["wv"],
        "B_wo": _B_in["wo"],
        "gate_w": _w((lambda *s: torch.randn(*s, dtype=torch.bfloat16) * 0.05)(576) * 16.0),
    }

def reference(A_x, A_dft_seq_re, A_dft_seq_im, A_dft_hid_re, A_dft_hid_im, B_x, B_wq, B_wk, B_wv, B_wo, gate_w):
    def _A_ref(x, dft_seq_re, dft_seq_im, dft_hid_re, dft_hid_im):
        a = torch.einsum("bsd,ed->bse", x, dft_hid_re)
        b = torch.einsum("bsd,ed->bse", x, dft_hid_im)
        y = torch.einsum("ts,bse->bte", dft_seq_re, a) - torch.einsum("ts,bse->bte", dft_seq_im, b)
        return y

    def _B_ref(x, wq, wk, wv, wo):
        B, S, D = x.shape
        H = 32
        Dh = D // H
        q = (lambda x, *d: x.permute(*d))((x @ wq).reshape(B, S, H, Dh), 0, 2, 1, 3)
        k = x @ wk
        v = x @ wv
        scores = torch.einsum("bhqd,bkd->bhqk", q, k) * (Dh ** -0.5)
        p = _softmax(scores, axis=-1)
        o = torch.einsum("bhqk,bkd->bhqd", p, v)
        return (lambda x, *d: x.permute(*d))(o, 0, 2, 1, 3).reshape(B, S, H * Dh) @ wo

    x = A_x
    g = _sigmoid((x * gate_w).sum(-1, keepdims=True))
    a = _A_ref(x, A_dft_seq_re, A_dft_seq_im, A_dft_hid_re, A_dft_hid_im)
    b = _B_ref(x, B_wq, B_wk, B_wv, B_wo)
    return g * a + (1 - g) * b
```

```asm
; @launch grid=(256,1,1) block=(768,1,1) lds=163840
.amdgcn_target "amdgcn-amd-amdhsa--gfx950"
.text
.globl gated_mix__spectral_fnet__grouped_kv_mqa__prompt_kernel
.p2align 8
.type gated_mix__spectral_fnet__grouped_kv_mqa__prompt_kernel,@function
gated_mix__spectral_fnet__grouped_kv_mqa__prompt_kernel:
f_code:
    s_cmp_ge_u32 s2, 256
    s_cbranch_scc1 f_end
    s_load_dwordx2 s[52:53], s[0:1], 104
    s_load_dwordx16 s[16:31], s[0:1], 0
    s_load_dwordx8 s[32:39], s[0:1], 64
    v_lshrrev_b32 v2, 6, v0
    v_and_b32 v1, 63, v0
    v_readfirstlane_b32 s56, v2
    s_bfe_u32 s3, s2, 0x20003
    s_lshr_b32 s67, s2, 6
    s_add_u32 s67, s67, s3
    s_and_b32 s67, s67, 3
    s_lshl_b32 s67, s67, 1
    s_and_b32 s57, s2, 7
    s_lshl_b32 s3, s3, 3
    s_add_u32 s57, s57, s3
    s_lshr_b32 s58, s2, 5
    s_mov_b32 s68, 0
    s_mov_b32 s69, -1
    s_cmp_ge_u32 s56, 4
    s_cbranch_scc1 f_att
    s_setprio 3
    s_cmp_eq_u32 s56, 0
    s_cbranch_scc1 f_duty
    s_sub_u32 s70, s56, 1
    v_lshrrev_b32 v8, 4, v1
    v_xor_b32 v8, v8, v1
    v_and_b32 v8, 3, v8
    v_lshlrev_b32 v8, 4, v8
    v_lshrrev_b32 v9, 2, v1
    s_mov_b32 s3, 73728
    v_mad_u32_u24 v2, v9, s3, v8
    v_and_b32 v10, 3, v1
    v_mul_u32_u24 v9, 36, v9
    v_lshl_add_u32 v3, v10, 4, v9
    s_and_b32 s59, s58, 1
    s_mul_i32 s75, s59, 36864
    s_lshl_b32 s59, s59, 5
    s_add_u32 s59, s59, s57
    s_mul_i32 s71, s59, 1152
    s_cmp_lt_u32 s58, 4
    s_cselect_b32 s42, 20736, 0
    s_cselect_b32 s72, -1, 0
    s_mov_b32 s73, 160768
    s_cmov_b32 s73, 73728
    s_mov_b32 s14, 2359296
    s_mov_b32 s15, 0x20000
    s_mov_b32 s43, 0x20000
    s_mov_b32 s60, s70
    s_barrier
    s_cmp_lt_u32 s58, 2
    s_waitcnt lgkmcnt(0)
    s_cselect_b64 s[40:41], s[30:31], s[32:33]
    s_mov_b64 s[12:13], s[16:17]
f_lL:
    s_lshl_b32 s61, s67, 1
    s_add_u32 s61, s61, s60
    s_cmp_ge_u32 s61, 18
    s_cselect_b32 s3, 18, 0
    s_sub_u32 s61, s61, s3
    s_lshl_b32 s62, s60, 11
    s_add_u32 m0, s62, s75
    s_lshl_b32 s3, s61, 6
    s_add_u32 s3, s3, s71
    buffer_load_dwordx4 v2, s[12:15], s3 offen lds
    s_add_u32 m0, m0, 1024
    s_add_u32 s3, s3, 1179648
    buffer_load_dwordx4 v2, s[12:15], s3 offen lds
    s_and_b32 s3, s62, s72
    s_add_u32 m0, s3, s73
    s_mul_i32 s3, s61, 1152
    buffer_load_dwordx4 v3, s[40:43], s3 offen lds
    s_add_u32 m0, m0, 448
    s_nop 0
    buffer_load_dwordx4 v3, s[40:43], s3 offen offset:576 lds
    s_add_u32 s60, s60, 3
    s_cmp_lt_u32 s60, 9
    s_cbranch_scc1 f_lL
    s_load_dwordx2 s[54:55], s[52:53], 0
    s_mov_b32 s8, s52
    s_mov_b32 s9, s53
    s_mov_b32 s10, 19922944
    s_mov_b32 s11, 0x20000
    s_mov_b32 s48, s28
    s_mov_b32 s49, s29
    s_mov_b32 s50, 663552
    s_mov_b32 s51, 0x20000
    s_mul_i32 s61, s70, 3
    s_add_u32 s61, s61, 0
    s_lshl_b32 s3, s61, 6
    v_add_u32 v8, s3, v1
    v_mul_u32_u24 v9, 7282, v8
    v_lshrrev_b32 v9, 16, v9
    v_mul_u32_u24 v10, 9, v9
    v_sub_u32 v8, v8, v10
    v_lshlrev_b32 v8, 4, v8
    v_and_b32 v10, 3, v9
    v_bfe_u32 v11, v9, 2, 2
    v_and_b32 v9, 48, v9
    v_lshl_add_u32 v9, v10, 2, v9
    v_add_u32 v9, v9, v11
    s_movk_i32 s3, 1152
    v_mad_u32_u24 v12, v9, s3, v8
    s_mul_i32 s61, s70, 3
    s_add_u32 s61, s61, 1
    s_lshl_b32 s3, s61, 6
    v_add_u32 v8, s3, v1
    v_mul_u32_u24 v9, 7282, v8
    v_lshrrev_b32 v9, 16, v9
    v_mul_u32_u24 v10, 9, v9
    v_sub_u32 v8, v8, v10
    v_lshlrev_b32 v8, 4, v8
    v_and_b32 v10, 3, v9
    v_bfe_u32 v11, v9, 2, 2
    v_and_b32 v9, 48, v9
    v_lshl_add_u32 v9, v10, 2, v9
    v_add_u32 v9, v9, v11
    s_movk_i32 s3, 1152
    v_mad_u32_u24 v13, v9, s3, v8
    s_mul_i32 s61, s70, 3
    s_add_u32 s61, s61, 2
    s_lshl_b32 s3, s61, 6
    v_add_u32 v8, s3, v1
    v_mul_u32_u24 v9, 7282, v8
    v_lshrrev_b32 v9, 16, v9
    v_mul_u32_u24 v10, 9, v9
    v_sub_u32 v8, v8, v10
    v_lshlrev_b32 v8, 4, v8
    v_and_b32 v10, 3, v9
    v_bfe_u32 v11, v9, 2, 2
    v_and_b32 v9, 48, v9
    v_lshl_add_u32 v9, v10, 2, v9
    v_add_u32 v9, v9, v11
    s_movk_i32 s3, 1152
    v_mad_u32_u24 v14, v9, s3, v8
    s_lshl_b32 s3, s70, 2
    s_add_u32 s3, s3, 159840
    v_mov_b32 v4, s3
    v_mov_b32 v6, 1
    v_mov_b32 v5, 159832
    s_mul_i32 s63, s58, 144
    s_mul_i32 s64, s70, 3072
    s_and_b32 s59, s58, 1
    s_xor_b32 s59, s59, 1
    s_mul_i32 s77, s59, 36864
    s_lshl_b32 s3, s70, 10
    s_add_u32 s77, s77, s3
    s_lshl_b32 s59, s59, 5
    s_add_u32 s59, s59, s57
    s_mul_i32 s76, s59, 1152
    s_mul_i32 s3, s70, 1179648
    s_add_u32 s76, s76, s3
    s_cmp_lg_u32 s56, 3
    s_cbranch_scc1 f_lM
    s_mov_b32 s44, s36
    s_mov_b32 s45, s37
    s_mov_b32 s46, 1152
    s_mov_b32 s47, 0x20000
    s_lshl_b32 s3, s67, 7
    s_add_u32 s3, s3, 0
    v_lshlrev_b32 v9, 4, v1
    v_add_u32 v9, s3, v9
    v_subrev_u32 v10, 1152, v9
    v_min_u32 v9, v9, v10
    s_mov_b32 m0, 156672
    s_nop 0
    buffer_load_dwordx4 v9, s[44:47], 0 offen lds
    s_lshl_b32 s3, s67, 7
    s_add_u32 s3, s3, 1024
    v_lshlrev_b32 v9, 4, v1
    v_add_u32 v9, s3, v9
    v_subrev_u32 v10, 1152, v9
    v_min_u32 v9, v9, v10
    s_mov_b32 m0, 157696
    s_nop 0
    buffer_load_dwordx4 v9, s[44:47], 0 offen lds
f_lM:
    s_waitcnt vmcnt(8)
    ds_write_b32 v4, v6
    v_add_u32 v6, 1, v6
    s_lshl_b32 s61, s67, 1
    s_add_u32 s61, s61, s60
    s_cmp_ge_u32 s61, 18
    s_cselect_b32 s3, 18, 0
    s_sub_u32 s61, s61, s3
    s_lshl_b32 s62, s60, 11
    s_add_u32 m0, s62, s75
    s_lshl_b32 s3, s61, 6
    s_add_u32 s3, s3, s71
    buffer_load_dwordx4 v2, s[12:15], s3 offen lds
    s_add_u32 m0, m0, 1024
    s_add_u32 s3, s3, 1179648
    buffer_load_dwordx4 v2, s[12:15], s3 offen lds
    s_and_b32 s3, s62, s72
    s_add_u32 m0, s3, s73
    s_mul_i32 s3, s61, 1152
    buffer_load_dwordx4 v3, s[40:43], s3 offen lds
    s_add_u32 m0, m0, 448
    s_nop 0
    buffer_load_dwordx4 v3, s[40:43], s3 offen offset:576 lds
    s_add_u32 s60, s60, 3
    s_cmp_lt_u32 s60, 18
    s_cbranch_scc1 f_lM
    s_cmp_eq_u32 s56, 3
    s_cbranch_scc1 f_l3
    v_mov_b32 v9, 4
    s_waitcnt vmcnt(8)
    ds_write_b32 v4, v9
    s_add_u32 s61, s67, 0
    s_cmp_ge_u32 s61, 9
    s_cselect_b32 s3, 9, 0
    s_sub_u32 s61, s61, s3
    s_add_u32 m0, s77, 0
    s_lshl_b32 s3, s61, 7
    s_add_u32 s3, s3, s76
    buffer_load_dwordx4 v2, s[12:15], s3 offen lds
    s_add_u32 m0, m0, 1984
    s_nop 0
    buffer_load_dwordx4 v2, s[12:15], s3 offen offset:64 lds
    s_add_u32 m0, s64, 110592
    s_mul_i32 s3, s61, 73728
    s_add_u32 s3, s3, s63
    buffer_load_dwordx4 v12, s[48:51], s3 offen lds
    s_add_u32 m0, m0, 1024
    s_nop 0
    buffer_load_dwordx4 v13, s[48:51], s3 offen lds
    s_add_u32 m0, m0, 1024
    s_nop 0
    buffer_load_dwordx4 v14, s[48:51], s3 offen lds
    v_mov_b32 v9, 5
    s_waitcnt vmcnt(9)
    ds_write_b32 v4, v9
    v_mov_b32 v9, 6
    s_waitcnt vmcnt(5)
    ds_write_b32 v4, v9
    s_add_u32 s61, s67, 1
    s_cmp_ge_u32 s61, 9
    s_cselect_b32 s3, 9, 0
    s_sub_u32 s61, s61, s3
    s_add_u32 m0, s77, 4096
    s_lshl_b32 s3, s61, 7
    s_add_u32 s3, s3, s76
    buffer_load_dwordx4 v2, s[12:15], s3 offen lds
    s_add_u32 m0, m0, 1984
    s_nop 0
    buffer_load_dwordx4 v2, s[12:15], s3 offen offset:64 lds
    s_add_u32 m0, s64, 119808
    s_mul_i32 s3, s61, 73728
    s_add_u32 s3, s3, s63
    buffer_load_dwordx4 v12, s[48:51], s3 offen lds
    s_add_u32 m0, m0, 1024
    s_nop 0
    buffer_load_dwordx4 v13, s[48:51], s3 offen lds
    s_add_u32 m0, m0, 1024
    s_nop 0
    buffer_load_dwordx4 v14, s[48:51], s3 offen lds
    s_add_u32 s61, s67, 2
    s_cmp_ge_u32 s61, 9
    s_cselect_b32 s3, 9, 0
    s_sub_u32 s61, s61, s3
    s_add_u32 m0, s77, 8192
    s_lshl_b32 s3, s61, 7
    s_add_u32 s3, s3, s76
    buffer_load_dwordx4 v2, s[12:15], s3 offen lds
    s_add_u32 m0, m0, 1984
    s_nop 0
    buffer_load_dwordx4 v2, s[12:15], s3 offen offset:64 lds
    s_add_u32 m0, s64, 129024
    s_mul_i32 s3, s61, 73728
    s_add_u32 s3, s3, s63
    buffer_load_dwordx4 v12, s[48:51], s3 offen lds
    s_add_u32 m0, m0, 1024
    s_nop 0
    buffer_load_dwordx4 v13, s[48:51], s3 offen lds
    s_add_u32 m0, m0, 1024
    s_nop 0
    buffer_load_dwordx4 v14, s[48:51], s3 offen lds
    v_mov_b32 v9, 7
    s_waitcnt vmcnt(10)
    ds_write_b32 v4, v9
    s_add_u32 s61, s67, 3
    s_cmp_ge_u32 s61, 9
    s_cselect_b32 s3, 9, 0
    s_sub_u32 s61, s61, s3
    s_add_u32 m0, s77, 12288
    s_lshl_b32 s3, s61, 7
    s_add_u32 s3, s3, s76
    buffer_load_dwordx4 v2, s[12:15], s3 offen lds
    s_add_u32 m0, m0, 1984
    s_nop 0
    buffer_load_dwordx4 v2, s[12:15], s3 offen offset:64 lds
    s_add_u32 m0, s64, 138240
    s_mul_i32 s3, s61, 73728
    s_add_u32 s3, s3, s63
    buffer_load_dwordx4 v12, s[48:51], s3 offen lds
    s_add_u32 m0, m0, 1024
    s_nop 0
    buffer_load_dwordx4 v13, s[48:51], s3 offen lds
    s_add_u32 m0, m0, 1024
    s_nop 0
    buffer_load_dwordx4 v14, s[48:51], s3 offen lds
    v_mov_b32 v9, 8
    s_waitcnt vmcnt(10)
    ds_write_b32 v4, v9
    s_add_u32 s61, s67, 4
    s_cmp_ge_u32 s61, 9
    s_cselect_b32 s3, 9, 0
    s_sub_u32 s61, s61, s3
    s_add_u32 m0, s77, 16384
    s_lshl_b32 s3, s61, 7
    s_add_u32 s3, s3, s76
    buffer_load_dwordx4 v2, s[12:15], s3 offen lds
    s_add_u32 m0, m0, 1984
    s_nop 0
    buffer_load_dwordx4 v2, s[12:15], s3 offen offset:64 lds
    s_add_u32 m0, s64, 147456
    s_mul_i32 s3, s61, 73728
    s_add_u32 s3, s3, s63
    buffer_load_dwordx4 v12, s[48:51], s3 offen lds
    s_add_u32 m0, m0, 1024
    s_nop 0
    buffer_load_dwordx4 v13, s[48:51], s3 offen lds
    s_add_u32 m0, m0, 1024
    s_nop 0
    buffer_load_dwordx4 v14, s[48:51], s3 offen lds
    v_mov_b32 v9, 9
    s_waitcnt vmcnt(10)
    ds_write_b32 v4, v9
f_l1w:
    ds_read_b32 v9, v5
    s_waitcnt lgkmcnt(0)
    v_cmp_gt_i32 vcc, 1, v9
    s_cbranch_vccnz f_l1w
    s_add_u32 s61, s67, 5
    s_cmp_ge_u32 s61, 9
    s_cselect_b32 s3, 9, 0
    s_sub_u32 s61, s61, s3
    s_add_u32 m0, s77, 20480
    s_lshl_b32 s3, s61, 7
    s_add_u32 s3, s3, s76
    buffer_load_dwordx4 v2, s[12:15], s3 offen lds
    s_add_u32 m0, m0, 1984
    s_nop 0
    buffer_load_dwordx4 v2, s[12:15], s3 offen offset:64 lds
    s_add_u32 m0, s64, 73728
    s_mul_i32 s3, s61, 73728
    s_add_u32 s3, s3, s63
    buffer_load_dwordx4 v12, s[48:51], s3 offen lds
    s_add_u32 m0, m0, 1024
    s_nop 0
    buffer_load_dwordx4 v13, s[48:51], s3 offen lds
    s_add_u32 m0, m0, 1024
    s_nop 0
    buffer_load_dwordx4 v14, s[48:51], s3 offen lds
    v_mov_b32 v9, 10
    s_waitcnt vmcnt(10)
    ds_write_b32 v4, v9
    s_add_u32 s61, s67, 6
    s_cmp_ge_u32 s61, 9
    s_cselect_b32 s3, 9, 0
    s_sub_u32 s61, s61, s3
    s_add_u32 m0, s77, 24576
    s_lshl_b32 s3, s61, 7
    s_add_u32 s3, s3, s76
    buffer_load_dwordx4 v2, s[12:15], s3 offen lds
    s_add_u32 m0, m0, 1984
    s_nop 0
    buffer_load_dwordx4 v2, s[12:15], s3 offen offset:64 lds
    s_add_u32 m0, s64, 82944
    s_mul_i32 s3, s61, 73728
    s_add_u32 s3, s3, s63
    buffer_load_dwordx4 v12, s[48:51], s3 offen lds
    s_add_u32 m0, m0, 1024
    s_nop 0
    buffer_load_dwordx4 v13, s[48:51], s3 offen lds
    s_add_u32 m0, m0, 1024
    s_nop 0
    buffer_load_dwordx4 v14, s[48:51], s3 offen lds
    v_mov_b32 v9, 11
    s_waitcnt vmcnt(10)
    ds_write_b32 v4, v9
    s_add_u32 s61, s67, 7
    s_cmp_ge_u32 s61, 9
    s_cselect_b32 s3, 9, 0
    s_sub_u32 s61, s61, s3
    s_add_u32 m0, s77, 28672
    s_lshl_b32 s3, s61, 7
    s_add_u32 s3, s3, s76
    buffer_load_dwordx4 v2, s[12:15], s3 offen lds
    s_add_u32 m0, m0, 1984
    s_nop 0
    buffer_load_dwordx4 v2, s[12:15], s3 offen offset:64 lds
    s_add_u32 m0, s64, 92160
    s_mul_i32 s3, s61, 73728
    s_add_u32 s3, s3, s63
    buffer_load_dwordx4 v12, s[48:51], s3 offen lds
    s_add_u32 m0, m0, 1024
    s_nop 0
    buffer_load_dwordx4 v13, s[48:51], s3 offen lds
    s_add_u32 m0, m0, 1024
    s_nop 0
    buffer_load_dwordx4 v14, s[48:51], s3 offen lds
    v_mov_b32 v9, 12
    s_waitcnt vmcnt(10)
    ds_write_b32 v4, v9
    s_add_u32 s61, s67, 8
    s_cmp_ge_u32 s61, 9
    s_cselect_b32 s3, 9, 0
    s_sub_u32 s61, s61, s3
    s_add_u32 m0, s77, 32768
    s_lshl_b32 s3, s61, 7
    s_add_u32 s3, s3, s76
    buffer_load_dwordx4 v2, s[12:15], s3 offen lds
    s_add_u32 m0, m0, 1984
    s_nop 0
    buffer_load_dwordx4 v2, s[12:15], s3 offen offset:64 lds
    s_add_u32 m0, s64, 101376
    s_mul_i32 s3, s61, 73728
    s_add_u32 s3, s3, s63
    buffer_load_dwordx4 v12, s[48:51], s3 offen lds
    s_add_u32 m0, m0, 1024
    s_nop 0
    buffer_load_dwordx4 v13, s[48:51], s3 offen lds
    s_add_u32 m0, m0, 1024
    s_nop 0
    buffer_load_dwordx4 v14, s[48:51], s3 offen lds
    v_mov_b32 v9, 13
    s_waitcnt vmcnt(10)
    ds_write_b32 v4, v9
    v_mov_b32 v9, 14
    s_waitcnt vmcnt(5)
    ds_write_b32 v4, v9
    v_mov_b32 v9, 15
    s_waitcnt vmcnt(0)
    ds_write_b32 v4, v9
    s_branch f_l4
f_l3:
    v_mov_b32 v9, 4
    s_waitcnt vmcnt(8)
    ds_write_b32 v4, v9
    s_add_u32 s61, s67, 0
    s_cmp_ge_u32 s61, 9
    s_cselect_b32 s3, 9, 0
    s_sub_u32 s61, s61, s3
    s_add_u32 m0, s64, 110592
    s_mul_i32 s3, s61, 73728
    s_add_u32 s3, s3, s63
    buffer_load_dwordx4 v12, s[48:51], s3 offen lds
    s_add_u32 m0, m0, 1024
    s_nop 0
    buffer_load_dwordx4 v13, s[48:51], s3 offen lds
    s_add_u32 m0, m0, 1024
    s_nop 0
    buffer_load_dwordx4 v14, s[48:51], s3 offen lds
    v_mov_b32 v9, 5
    s_waitcnt vmcnt(7)
    ds_write_b32 v4, v9
    v_mov_b32 v9, 6
    s_waitcnt vmcnt(3)
    ds_write_b32 v4, v9
    s_add_u32 s61, s67, 1
    s_cmp_ge_u32 s61, 9
    s_cselect_b32 s3, 9, 0
    s_sub_u32 s61, s61, s3
    s_add_u32 m0, s64, 119808
    s_mul_i32 s3, s61, 73728
    s_add_u32 s3, s3, s63
    buffer_load_dwordx4 v12, s[48:51], s3 offen lds
    s_add_u32 m0, m0, 1024
    s_nop 0
    buffer_load_dwordx4 v13, s[48:51], s3 offen lds
    s_add_u32 m0, m0, 1024
    s_nop 0
    buffer_load_dwordx4 v14, s[48:51], s3 offen lds
    s_add_u32 s61, s67, 2
    s_cmp_ge_u32 s61, 9
    s_cselect_b32 s3, 9, 0
    s_sub_u32 s61, s61, s3
    s_add_u32 m0, s64, 129024
    s_mul_i32 s3, s61, 73728
    s_add_u32 s3, s3, s63
    buffer_load_dwordx4 v12, s[48:51], s3 offen lds
    s_add_u32 m0, m0, 1024
    s_nop 0
    buffer_load_dwordx4 v13, s[48:51], s3 offen lds
    s_add_u32 m0, m0, 1024
    s_nop 0
    buffer_load_dwordx4 v14, s[48:51], s3 offen lds
    v_mov_b32 v9, 7
    s_waitcnt vmcnt(6)
    ds_write_b32 v4, v9
    s_add_u32 s61, s67, 3
    s_cmp_ge_u32 s61, 9
    s_cselect_b32 s3, 9, 0
    s_sub_u32 s61, s61, s3
    s_add_u32 m0, s64, 138240
    s_mul_i32 s3, s61, 73728
    s_add_u32 s3, s3, s63
    buffer_load_dwordx4 v12, s[48:51], s3 offen lds
    s_add_u32 m0, m0, 1024
    s_nop 0
    buffer_load_dwordx4 v13, s[48:51], s3 offen lds
    s_add_u32 m0, m0, 1024
    s_nop 0
    buffer_load_dwordx4 v14, s[48:51], s3 offen lds
    v_mov_b32 v9, 8
    s_waitcnt vmcnt(6)
    ds_write_b32 v4, v9
    s_add_u32 s61, s67, 4
    s_cmp_ge_u32 s61, 9
    s_cselect_b32 s3, 9, 0
    s_sub_u32 s61, s61, s3
    s_add_u32 m0, s64, 147456
    s_mul_i32 s3, s61, 73728
    s_add_u32 s3, s3, s63
    buffer_load_dwordx4 v12, s[48:51], s3 offen lds
    s_add_u32 m0, m0, 1024
    s_nop 0
    buffer_load_dwordx4 v13, s[48:51], s3 offen lds
    s_add_u32 m0, m0, 1024
    s_nop 0
    buffer_load_dwordx4 v14, s[48:51], s3 offen lds
    v_mov_b32 v9, 9
    s_waitcnt vmcnt(6)
    ds_write_b32 v4, v9
f_l3w:
    ds_read_b32 v9, v5
    s_waitcnt lgkmcnt(0)
    v_cmp_gt_i32 vcc, 1, v9
    s_cbranch_vccnz f_l3w
    s_add_u32 s61, s67, 5
    s_cmp_ge_u32 s61, 9
    s_cselect_b32 s3, 9, 0
    s_sub_u32 s61, s61, s3
    s_add_u32 m0, s64, 73728
    s_mul_i32 s3, s61, 73728
    s_add_u32 s3, s3, s63
    buffer_load_dwordx4 v12, s[48:51], s3 offen lds
    s_add_u32 m0, m0, 1024
    s_nop 0
    buffer_load_dwordx4 v13, s[48:51], s3 offen lds
    s_add_u32 m0, m0, 1024
    s_nop 0
    buffer_load_dwordx4 v14, s[48:51], s3 offen lds
    v_mov_b32 v9, 10
    s_waitcnt vmcnt(6)
    ds_write_b32 v4, v9
    s_add_u32 s61, s67, 6
    s_cmp_ge_u32 s61, 9
    s_cselect_b32 s3, 9, 0
    s_sub_u32 s61, s61, s3
    s_add_u32 m0, s64, 82944
    s_mul_i32 s3, s61, 73728
    s_add_u32 s3, s3, s63
    buffer_load_dwordx4 v12, s[48:51], s3 offen lds
    s_add_u32 m0, m0, 1024
    s_nop 0
    buffer_load_dwordx4 v13, s[48:51], s3 offen lds
    s_add_u32 m0, m0, 1024
    s_nop 0
    buffer_load_dwordx4 v14, s[48:51], s3 offen lds
    v_mov_b32 v9, 11
    s_waitcnt vmcnt(6)
    ds_write_b32 v4, v9
    s_add_u32 s61, s67, 7
    s_cmp_ge_u32 s61, 9
    s_cselect_b32 s3, 9, 0
    s_sub_u32 s61, s61, s3
    s_add_u32 m0, s64, 92160
    s_mul_i32 s3, s61, 73728
    s_add_u32 s3, s3, s63
    buffer_load_dwordx4 v12, s[48:51], s3 offen lds
    s_add_u32 m0, m0, 1024
    s_nop 0
    buffer_load_dwordx4 v13, s[48:51], s3 offen lds
    s_add_u32 m0, m0, 1024
    s_nop 0
    buffer_load_dwordx4 v14, s[48:51], s3 offen lds
    v_mov_b32 v9, 12
    s_waitcnt vmcnt(6)
    ds_write_b32 v4, v9
    s_add_u32 s61, s67, 8
    s_cmp_ge_u32 s61, 9
    s_cselect_b32 s3, 9, 0
    s_sub_u32 s61, s61, s3
    s_add_u32 m0, s64, 101376
    s_mul_i32 s3, s61, 73728
    s_add_u32 s3, s3, s63
    buffer_load_dwordx4 v12, s[48:51], s3 offen lds
    s_add_u32 m0, m0, 1024
    s_nop 0
    buffer_load_dwordx4 v13, s[48:51], s3 offen lds
    s_add_u32 m0, m0, 1024
    s_nop 0
    buffer_load_dwordx4 v14, s[48:51], s3 offen lds
    v_mov_b32 v9, 13
    s_waitcnt vmcnt(6)
    ds_write_b32 v4, v9
    v_mov_b32 v9, 14
    s_waitcnt vmcnt(3)
    ds_write_b32 v4, v9
    v_mov_b32 v9, 15
    s_waitcnt vmcnt(0)
    ds_write_b32 v4, v9
f_l4:
    v_lshlrev_b32 v156, 4, v1
    s_lshl_b32 s3, s56, 2
    s_add_u32 s3, s3, 159744
    v_mov_b32 v117, s3
    v_and_b32 v9, 15, v1
    v_min_u32 v9, 8, v9
    v_lshlrev_b32 v9, 2, v9
    v_add_u32 v9, 159760, v9
    s_mul_i32 s59, s57, 4864
    s_lshl_b32 s60, s56, 12
    s_add_u32 m0, s60, 110592
    s_add_u32 s59, s59, s60
    s_add_u32 s59, s59, 327680
    v_mov_b32 v6, 1
    v_mov_b32 v4, 159796
f_kv2:
    ds_read_b32 v10, v9
    s_waitcnt lgkmcnt(0)
    v_cmp_gt_i32 vcc, 1, v10
    s_cbranch_vccnz f_kv2
    buffer_load_dwordx4 v156, s[8:11], s59 offen offset:0 sc1 lds
    buffer_load_dwordx4 v156, s[8:11], s59 offen offset:1024 sc1 lds
    buffer_load_dwordx4 v156, s[8:11], s59 offen offset:2048 sc1 lds
    buffer_load_dwordx4 v156, s[8:11], s59 offen offset:3072 sc1 lds
    s_add_u32 s54, s54, 1
    s_add_u32 s6, s56, 0
    s_lshl_b32 s3, s6, 6
    v_add_u32 v8, s3, v1
    v_mul_u32_u24 v9, 7282, v8
    v_lshrrev_b32 v9, 16, v9
    v_mul_u32_u24 v10, 9, v9
    v_sub_u32 v8, v8, v10
    v_lshlrev_b32 v8, 4, v8
    v_and_b32 v10, 1, v9
    v_bfe_u32 v11, v9, 1, 2
    v_and_b32 v9, 56, v9
    v_lshl_add_u32 v9, v10, 2, v9
    v_add_u32 v9, v9, v11
    s_movk_i32 s3, 1280
    v_mad_u32_u24 v106, v9, s3, v8
    s_movk_i32 s3, 1152
    v_lshrrev_b32 v10, 4, v9
    v_lshl_add_u32 v10, v10, 1, v9
    v_mad_u32_u24 v100, v10, s3, v8
    v_lshrrev_b32 v10, 1, v9
    v_lshl_add_u32 v10, v10, 4, v9
    v_add_u32 v10, 16, v10
    v_mad_u32_u24 v103, v10, s3, v8
    v_add_u32 v9, 0, v1
    v_mul_u32_u24 v10, 7282, v9
    v_lshrrev_b32 v10, 16, v10
    v_lshlrev_b32 v9, 4, v9
    s_mov_b32 s3, 73584
    v_mad_u32_u24 v161, v10, s3, v9
    s_add_u32 s6, s56, 4
    s_lshl_b32 s3, s6, 6
    v_add_u32 v8, s3, v1
    v_mul_u32_u24 v9, 7282, v8
    v_lshrrev_b32 v9, 16, v9
    v_mul_u32_u24 v10, 9, v9
    v_sub_u32 v8, v8, v10
    v_lshlrev_b32 v8, 4, v8
    v_and_b32 v10, 1, v9
    v_bfe_u32 v11, v9, 1, 2
    v_and_b32 v9, 56, v9
    v_lshl_add_u32 v9, v10, 2, v9
    v_add_u32 v9, v9, v11
    s_movk_i32 s3, 1280
    v_mad_u32_u24 v107, v9, s3, v8
    s_movk_i32 s3, 1152
    v_lshrrev_b32 v10, 4, v9
    v_lshl_add_u32 v10, v10, 1, v9
    v_mad_u32_u24 v101, v10, s3, v8
    v_lshrrev_b32 v10, 1, v9
    v_lshl_add_u32 v10, v10, 4, v9
    v_add_u32 v10, 16, v10
    v_mad_u32_u24 v104, v10, s3, v8
    v_add_u32 v9, 64, v1
    v_mul_u32_u24 v10, 7282, v9
    v_lshrrev_b32 v10, 16, v10
    v_lshlrev_b32 v9, 4, v9
    s_mov_b32 s3, 73584
    v_mad_u32_u24 v162, v10, s3, v9
    s_add_u32 s6, s56, 8
    s_lshl_b32 s3, s6, 6
    v_add_u32 v8, s3, v1
    v_mul_u32_u24 v9, 7282, v8
    v_lshrrev_b32 v9, 16, v9
    v_mul_u32_u24 v10, 9, v9
    v_sub_u32 v8, v8, v10
    v_lshlrev_b32 v8, 4, v8
    v_and_b32 v10, 1, v9
    v_bfe_u32 v11, v9, 1, 2
    v_and_b32 v9, 56, v9
    v_lshl_add_u32 v9, v10, 2, v9
    v_add_u32 v9, v9, v11
    s_movk_i32 s3, 1280
    v_mad_u32_u24 v108, v9, s3, v8
    s_movk_i32 s3, 1152
    v_lshrrev_b32 v10, 4, v9
    v_lshl_add_u32 v10, v10, 1, v9
    v_mad_u32_u24 v102, v10, s3, v8
    v_lshrrev_b32 v10, 1, v9
    v_lshl_add_u32 v10, v10, 4, v9
    v_add_u32 v10, 16, v10
    v_mad_u32_u24 v105, v10, s3, v8
    v_add_u32 v9, 128, v1
    v_mul_u32_u24 v10, 7282, v9
    v_lshrrev_b32 v10, 16, v10
    v_lshlrev_b32 v9, 4, v9
    s_mov_b32 s3, 73584
    v_mad_u32_u24 v163, v10, s3, v9
    v_lshlrev_b32 v156, 4, v1
    v_lshrrev_b32 v10, 3, v1
    v_xor_b32 v11, v10, v1
    v_and_b32 v11, 7, v11
    v_lshlrev_b32 v11, 4, v11
    v_lshl_add_u32 v11, v10, 7, v11
    s_lshl_b32 s3, s56, 12
    s_add_u32 s3, s3, 81920
    v_add_u32 v109, s3, v11
    v_and_b32 v9, 7, v1
    v_lshlrev_b32 v160, 3, v9
    v_lshl_add_u32 v118, v10, 7, v160
    v_mul_u32_u24 v10, 163840, v10
    v_lshl_add_u32 v110, v9, 4, v10
    v_lshlrev_b32 v9, 2, v9
    v_add_u32 v113, 159760, v9
    v_and_b32 v9, 12, v9
    v_add_u32 v114, 159856, v9
    v_add_u32 v115, 159808, v9
    s_lshl_b32 s3, s56, 2
    s_add_u32 s6, s3, 159808
    v_mov_b32 v116, s6
    s_add_u32 s6, s3, 159744
    v_mov_b32 v117, s6
    v_and_b32 v8, 15, v1
    v_lshrrev_b32 v10, 4, v1
    v_lshlrev_b32 v9, 2, v8
    v_lshl_add_u32 v159, v10, 9, v9
    s_lshl_b32 s3, s56, 6
    s_add_u32 s3, s3, 160000
    v_add_u32 v112, s3, v9
    s_and_b32 s3, s56, 1
    s_lshl_b32 s3, s3, 22
    v_lshlrev_b32 v9, 18, v8
    v_lshl_add_u32 v9, v10, 4, v9
    v_add_u32 v111, s3, v9
    s_mul_i32 s3, s56, 2304
    s_add_u32 s3, s3, 57344
    v_mul_u32_u24 v9, 144, v8
    v_lshl_add_u32 v9, v10, 3, v9
    v_add_u32 v164, s3, v9
    v_add_u32 v165, s3, v156
    v_bfe_u32 v11, v1, 2, 2
    v_lshl_add_u32 v10, v10, 2, v11
    v_mul_u32_u24 v10, 288, v10
    v_and_b32 v11, 3, v1
    v_lshl_add_u32 v157, v11, 3, v10
    v_add_u32 v158, 110592, v157
    s_waitcnt vmcnt(0)
    ds_write_b32 v117, v6
    s_branch f_h1
f_duty:
    v_lshlrev_b32 v8, 2, v1
    v_add_u32 v8, 159744, v8
    s_cmp_ge_u32 s58, 4
    s_cselect_b32 s6, 4194304, 0
    s_mov_b32 s7, 0
    v_cndmask_b32 v9, 0, 2, s[6:7]
    ds_write_b32 v8, v9
    v_lshrrev_b32 v10, 5, v1
    v_lshrrev_b32 v11, 2, v1
    v_xor_b32 v10, v10, v11
    v_and_b32 v10, 3, v10
    v_and_b32 v11, 31, v1
    v_lshlrev_b32 v11, 6, v11
    v_lshl_add_u32 v2, v10, 4, v11
    s_waitcnt lgkmcnt(0)
    s_load_dwordx2 s[54:55], s[52:53], 0
    s_mov_b32 s8, s52
    s_mov_b32 s9, s53
    s_mov_b32 s10, 19922944
    s_mov_b32 s11, 0x20000
    s_barrier
    s_and_b32 s59, s58, 1
    s_lshl_b32 s70, s59, 5
    s_add_u32 s70, s70, s57
    s_mul_i32 s59, s59, 36864
    v_add_u32 v2, s59, v2
    v_xor_b32 v3, 32, v2
    v_and_b32 v4, 3, v1
    v_min_u32 v4, 2, v4
    v_lshlrev_b32 v4, 2, v4
    v_add_u32 v4, 159840, v4
    s_cmp_ge_u32 s58, 4
    s_cbranch_scc1 f_cF
    v_and_b32 v10, 3, v1
    v_and_b32 v8, 1, v1
    v_bfe_u32 v11, v1, 1, 1
    v_lshl_or_b32 v8, v8, 1, v11
    v_bfe_u32 v11, v1, 4, 1
    v_cmp_eq_u32 vcc, 0, v11
    v_bfe_u32 v6, v1, 2, 2
    v_lshrrev_b32 v7, 5, v1
    v_cndmask_b32 v8, v10, v8, vcc
    v_lshl_add_u32 v6, v7, 3, v6
    v_lshlrev_b32 v6, 6, v6
    v_lshl_add_u32 v6, v11, 5, v6
    v_lshl_add_u32 v6, v8, 3, v6
    v_add_u32 v6, 73728, v6
    s_cmp_ge_u32 s58, 2
    s_cbranch_scc1 f_cV
    s_and_b32 s59, s58, 1
    s_lshl_b32 s60, s57, 1
    s_add_u32 s59, s59, s60
    s_mul_i32 s64, s59, 2432
    s_add_u32 s64, s64, 327680
    s_add_u32 s63, s64, 155648
    v_lshlrev_b32 v14, 4, v1
    v_lshlrev_b32 v15, 2, v1
f_dK0:
    ds_read_b32 v8, v4
    s_waitcnt lgkmcnt(0)
    v_cmp_gt_i32 vcc, 2, v8
    s_cbranch_vccnz f_dK0
    ds_read_b128 v[32:35], v2 offset:0
    ds_read_b64_tr_b16 v[36:37], v6 offset:0
    ds_read_b64_tr_b16 v[38:39], v6 offset:256
    ds_read_b128 v[40:43], v3 offset:0
    ds_read_b64_tr_b16 v[44:45], v6 offset:1024
    ds_read_b64_tr_b16 v[46:47], v6 offset:1280
    ds_read_b128 v[48:51], v2 offset:2048
    ds_read_b64_tr_b16 v[52:53], v6 offset:2048
    ds_read_b64_tr_b16 v[54:55], v6 offset:2304
    ds_read_b128 v[56:59], v3 offset:2048
    ds_read_b64_tr_b16 v[60:61], v6 offset:3072
    ds_read_b64_tr_b16 v[62:63], v6 offset:3328
    s_waitcnt lgkmcnt(9)
    v_mfma_f32_32x32x16_bf16 v[16:31], v[36:39], v[32:35], 0
    s_waitcnt lgkmcnt(6)
    ds_read_b128 v[64:67], v2 offset:4096
    ds_read_b64_tr_b16 v[68:69], v6 offset:4096
    ds_read_b64_tr_b16 v[70:71], v6 offset:4352
    ds_read_b128 v[72:75], v3 offset:4096
    ds_read_b64_tr_b16 v[76:77], v6 offset:5120
    ds_read_b64_tr_b16 v[78:79], v6 offset:5376
    v_mfma_f32_32x32x16_bf16 v[16:31], v[44:47], v[40:43], v[16:31]
    s_waitcnt lgkmcnt(9)
    v_mfma_f32_32x32x16_bf16 v[16:31], v[52:55], v[48:51], v[16:31]
    s_waitcnt lgkmcnt(6)
    ds_read_b128 v[32:35], v2 offset:6144
    ds_read_b64_tr_b16 v[36:37], v6 offset:6144
    ds_read_b64_tr_b16 v[38:39], v6 offset:6400
    ds_read_b128 v[40:43], v3 offset:6144
    ds_read_b64_tr_b16 v[44:45], v6 offset:7168
    ds_read_b64_tr_b16 v[46:47], v6 offset:7424
    v_mfma_f32_32x32x16_bf16 v[16:31], v[60:63], v[56:59], v[16:31]
    s_waitcnt lgkmcnt(9)
    v_mfma_f32_32x32x16_bf16 v[16:31], v[68:71], v[64:67], v[16:31]
    s_waitcnt lgkmcnt(6)
    ds_read_b128 v[48:51], v2 offset:8192
    ds_read_b64_tr_b16 v[52:53], v6 offset:8192
    ds_read_b64_tr_b16 v[54:55], v6 offset:8448
    ds_read_b128 v[56:59], v3 offset:8192
    ds_read_b64_tr_b16 v[60:61], v6 offset:9216
    ds_read_b64_tr_b16 v[62:63], v6 offset:9472
    v_mfma_f32_32x32x16_bf16 v[16:31], v[76:79], v[72:75], v[16:31]
    s_waitcnt lgkmcnt(9)
    v_mfma_f32_32x32x16_bf16 v[16:31], v[36:39], v[32:35], v[16:31]
    s_waitcnt lgkmcnt(6)
    ds_read_b32 v8, v4
    ds_read_b128 v[64:67], v2 offset:10240
    ds_read_b64_tr_b16 v[68:69], v6 offset:10240
    ds_read_b64_tr_b16 v[70:71], v6 offset:10496
    ds_read_b128 v[72:75], v3 offset:10240
    ds_read_b64_tr_b16 v[76:77], v6 offset:11264
    ds_read_b64_tr_b16 v[78:79], v6 offset:11520
    v_mfma_f32_32x32x16_bf16 v[16:31], v[44:47], v[40:43], v[16:31]
    s_waitcnt lgkmcnt(6)
    v_cmp_gt_i32 vcc, 4, v8
    s_cbranch_vccz f_dK4_ok
f_dK4:
    ds_read_b32 v8, v4
    s_waitcnt lgkmcnt(0)
    v_cmp_gt_i32 vcc, 4, v8
    s_cbranch_vccnz f_dK4
f_dK4_ok:
    v_mfma_f32_32x32x16_bf16 v[16:31], v[52:55], v[48:51], v[16:31]
    ds_read_b128 v[32:35], v2 offset:12288
    ds_read_b64_tr_b16 v[36:37], v6 offset:12288
    ds_read_b64_tr_b16 v[38:39], v6 offset:12544
    ds_read_b128 v[40:43], v3 offset:12288
    ds_read_b64_tr_b16 v[44:45], v6 offset:13312
    ds_read_b64_tr_b16 v[46:47], v6 offset:13568
    v_mfma_f32_32x32x16_bf16 v[16:31], v[60:63], v[56:59], v[16:31]
    s_waitcnt lgkmcnt(9)
    v_mfma_f32_32x32x16_bf16 v[16:31], v[68:71], v[64:67], v[16:31]
    s_waitcnt lgkmcnt(6)
    ds_read_b128 v[48:51], v2 offset:14336
    ds_read_b64_tr_b16 v[52:53], v6 offset:14336
    ds_read_b64_tr_b16 v[54:55], v6 offset:14592
    ds_read_b128 v[56:59], v3 offset:14336
    ds_read_b64_tr_b16 v[60:61], v6 offset:15360
    ds_read_b64_tr_b16 v[62:63], v6 offset:15616
    v_mfma_f32_32x32x16_bf16 v[16:31], v[76:79], v[72:75], v[16:31]
    s_waitcnt lgkmcnt(9)
    v_mfma_f32_32x32x16_bf16 v[16:31], v[36:39], v[32:35], v[16:31]
    s_waitcnt lgkmcnt(6)
    ds_read_b128 v[64:67], v2 offset:16384
    ds_read_b64_tr_b16 v[68:69], v6 offset:16384
    ds_read_b64_tr_b16 v[70:71], v6 offset:16640
    ds_read_b128 v[72:75], v3 offset:16384
    ds_read_b64_tr_b16 v[76:77], v6 offset:17408
    ds_read_b64_tr_b16 v[78:79], v6 offset:17664
    v_mfma_f32_32x32x16_bf16 v[16:31], v[44:47], v[40:43], v[16:31]
    s_waitcnt lgkmcnt(9)
    v_mfma_f32_32x32x16_bf16 v[16:31], v[52:55], v[48:51], v[16:31]
    s_waitcnt lgkmcnt(6)
    ds_read_b128 v[32:35], v2 offset:18432
    ds_read_b64_tr_b16 v[36:37], v6 offset:18432
    ds_read_b64_tr_b16 v[38:39], v6 offset:18688
    ds_read_b128 v[40:43], v3 offset:18432
    ds_read_b64_tr_b16 v[44:45], v6 offset:19456
    ds_read_b64_tr_b16 v[46:47], v6 offset:19712
    v_mfma_f32_32x32x16_bf16 v[16:31], v[60:63], v[56:59], v[16:31]
    s_waitcnt lgkmcnt(9)
    v_mfma_f32_32x32x16_bf16 v[16:31], v[68:71], v[64:67], v[16:31]
    s_waitcnt lgkmcnt(6)
    ds_read_b128 v[48:51], v2 offset:20480
    ds_read_b64_tr_b16 v[52:53], v6 offset:20480
    ds_read_b64_tr_b16 v[54:55], v6 offset:20736
    ds_read_b128 v[56:59], v3 offset:20480
    ds_read_b64_tr_b16 v[60:61], v6 offset:21504
    ds_read_b64_tr_b16 v[62:63], v6 offset:21760
    v_mfma_f32_32x32x16_bf16 v[16:31], v[76:79], v[72:75], v[16:31]
    s_waitcnt lgkmcnt(9)
    v_mfma_f32_32x32x16_bf16 v[16:31], v[36:39], v[32:35], v[16:31]
    s_waitcnt lgkmcnt(6)
    ds_read_b32 v8, v4
    ds_read_b128 v[64:67], v2 offset:22528
    ds_read_b64_tr_b16 v[68:69], v6 offset:22528
    ds_read_b64_tr_b16 v[70:71], v6 offset:22784
    ds_read_b128 v[72:75], v3 offset:22528
    ds_read_b64_tr_b16 v[76:77], v6 offset:23552
    ds_read_b64_tr_b16 v[78:79], v6 offset:23808
    v_mfma_f32_32x32x16_bf16 v[16:31], v[44:47], v[40:43], v[16:31]
    s_waitcnt lgkmcnt(6)
    v_cmp_gt_i32 vcc, 6, v8
    s_cbranch_vccz f_dK10_ok
f_dK10:
    ds_read_b32 v8, v4
    s_waitcnt lgkmcnt(0)
    v_cmp_gt_i32 vcc, 6, v8
    s_cbranch_vccnz f_dK10
f_dK10_ok:
    v_mfma_f32_32x32x16_bf16 v[16:31], v[52:55], v[48:51], v[16:31]
    ds_read_b128 v[32:35], v2 offset:24576
    ds_read_b64_tr_b16 v[36:37], v6 offset:24576
    ds_read_b64_tr_b16 v[38:39], v6 offset:24832
    ds_read_b128 v[40:43], v3 offset:24576
    ds_read_b64_tr_b16 v[44:45], v6 offset:25600
    ds_read_b64_tr_b16 v[46:47], v6 offset:25856
    v_mfma_f32_32x32x16_bf16 v[16:31], v[60:63], v[56:59], v[16:31]
    s_waitcnt lgkmcnt(9)
    v_mfma_f32_32x32x16_bf16 v[16:31], v[68:71], v[64:67], v[16:31]
    s_waitcnt lgkmcnt(6)
    ds_read_b128 v[48:51], v2 offset:26624
    ds_read_b64_tr_b16 v[52:53], v6 offset:26624
    ds_read_b64_tr_b16 v[54:55], v6 offset:26880
    ds_read_b128 v[56:59], v3 offset:26624
    ds_read_b64_tr_b16 v[60:61], v6 offset:27648
    ds_read_b64_tr_b16 v[62:63], v6 offset:27904
    v_mfma_f32_32x32x16_bf16 v[16:31], v[76:79], v[72:75], v[16:31]
    s_waitcnt lgkmcnt(9)
    v_mfma_f32_32x32x16_bf16 v[16:31], v[36:39], v[32:35], v[16:31]
    s_waitcnt lgkmcnt(6)
    ds_read_b128 v[64:67], v2 offset:28672
    ds_read_b64_tr_b16 v[68:69], v6 offset:28672
    ds_read_b64_tr_b16 v[70:71], v6 offset:28928
    ds_read_b128 v[72:75], v3 offset:28672
    ds_read_b64_tr_b16 v[76:77], v6 offset:29696
    ds_read_b64_tr_b16 v[78:79], v6 offset:29952
    v_mfma_f32_32x32x16_bf16 v[16:31], v[44:47], v[40:43], v[16:31]
    s_waitcnt lgkmcnt(9)
    v_mfma_f32_32x32x16_bf16 v[16:31], v[52:55], v[48:51], v[16:31]
    s_waitcnt lgkmcnt(6)
    ds_read_b128 v[32:35], v2 offset:30720
    ds_read_b64_tr_b16 v[36:37], v6 offset:30720
    ds_read_b64_tr_b16 v[38:39], v6 offset:30976
    ds_read_b128 v[40:43], v3 offset:30720
    ds_read_b64_tr_b16 v[44:45], v6 offset:31744
    ds_read_b64_tr_b16 v[46:47], v6 offset:32000
    v_mfma_f32_32x32x16_bf16 v[16:31], v[60:63], v[56:59], v[16:31]
    s_waitcnt lgkmcnt(9)
    v_mfma_f32_32x32x16_bf16 v[16:31], v[68:71], v[64:67], v[16:31]
    s_waitcnt lgkmcnt(6)
    ds_read_b128 v[48:51], v2 offset:32768
    ds_read_b64_tr_b16 v[52:53], v6 offset:32768
    ds_read_b64_tr_b16 v[54:55], v6 offset:33024
    ds_read_b128 v[56:59], v3 offset:32768
    ds_read_b64_tr_b16 v[60:61], v6 offset:33792
    ds_read_b64_tr_b16 v[62:63], v6 offset:34048
    v_mfma_f32_32x32x16_bf16 v[16:31], v[76:79], v[72:75], v[16:31]
    s_waitcnt lgkmcnt(9)
    v_mfma_f32_32x32x16_bf16 v[16:31], v[36:39], v[32:35], v[16:31]
    s_waitcnt lgkmcnt(6)
    ds_read_b128 v[64:67], v2 offset:34816
    ds_read_b64_tr_b16 v[68:69], v6 offset:34816
    ds_read_b64_tr_b16 v[70:71], v6 offset:35072
    ds_read_b128 v[72:75], v3 offset:34816
    ds_read_b64_tr_b16 v[76:77], v6 offset:35840
    ds_read_b64_tr_b16 v[78:79], v6 offset:36096
    v_mfma_f32_32x32x16_bf16 v[16:31], v[44:47], v[40:43], v[16:31]
    s_waitcnt lgkmcnt(9)
    v_mfma_f32_32x32x16_bf16 v[16:31], v[52:55], v[48:51], v[16:31]
    s_waitcnt lgkmcnt(6)
    v_mfma_f32_32x32x16_bf16 v[16:31], v[60:63], v[56:59], v[16:31]
    s_waitcnt lgkmcnt(3)
    v_mfma_f32_32x32x16_bf16 v[16:31], v[68:71], v[64:67], v[16:31]
    s_waitcnt lgkmcnt(0)
    v_mfma_f32_32x32x16_bf16 v[16:31], v[76:79], v[72:75], v[16:31]
    v_mov_b32 v8, 159832
    v_mov_b32 v9, 1
    ds_write_b32 v8, v9
    s_add_u32 s54, s54, 1
    s_nop 7
    v_cvt_pk_bf16_f32 v32, v16, v17
    v_cvt_pk_bf16_f32 v33, v18, v19
    v_cvt_pk_bf16_f32 v34, v20, v21
    v_cvt_pk_bf16_f32 v35, v22, v23
    v_cvt_pk_bf16_f32 v36, v24, v25
    buffer_store_dwordx4 v[32:35], v14, s[8:11], s64 offen sc1
    buffer_store_dwordx4 v[32:35], v14, s[8:11], s63 offen sc1
    s_mov_b32 exec_hi, 0
    buffer_store_dword v36, v15, s[8:11], s64 offen offset:1024 sc1
    buffer_store_dword v36, v15, s[8:11], s63 offen offset:1024 sc1
    s_mov_b32 exec_hi, -1
    s_branch f_dP
f_cV:
    s_and_b32 s59, s58, 1
    s_lshl_b32 s60, s57, 1
    s_add_u32 s59, s59, s60
    s_mul_i32 s64, s59, 2432
    s_add_u32 s64, s64, 327680
    s_add_u32 s63, s64, 155648
    v_and_b32 v8, 51, v1
    v_bfe_u32 v9, v1, 2, 1
    v_lshl_add_u32 v8, v9, 3, v8
    v_bfe_u32 v9, v1, 3, 1
    v_lshl_add_u32 v8, v9, 2, v8
    v_lshrrev_b32 v10, 5, v8
    v_lshrrev_b32 v11, 2, v8
    v_xor_b32 v10, v10, v11
    v_and_b32 v10, 3, v10
    v_and_b32 v11, 31, v8
    v_lshlrev_b32 v11, 6, v11
    v_lshl_add_u32 v2, v10, 4, v11
    s_and_b32 s3, s58, 1
    s_mul_i32 s3, s3, 36864
    v_add_u32 v2, s3, v2
    v_xor_b32 v3, 32, v2
    v_and_b32 v8, 31, v1
    v_lshrrev_b32 v10, 5, v1
    v_mul_u32_u24 v14, 19, v10
    v_add_u32 v14, v14, v8
    v_add_u32 v10, 38, v10
    v_cmp_eq_u32 vcc, 19, v8
    v_mov_b32 v11, 0x3f803f80
    s_nop 0
    v_cndmask_b32 v14, v14, v10, vcc
    v_cmp_eq_u32 vcc, 19, v1
    s_nop 1
    v_cndmask_b32 v80, v11, 0, vcc
    v_lshlrev_b32 v14, 4, v14
    v_mov_b32 v81, v80
    v_mov_b32 v82, v80
    v_mov_b32 v83, v80
    v_mov_b32 v84, v80
    v_mov_b32 v85, v80
    v_mov_b32 v86, v80
    v_mov_b32 v87, v80
f_dV0:
    ds_read_b32 v8, v4
    s_waitcnt lgkmcnt(0)
    v_cmp_gt_i32 vcc, 2, v8
    s_cbranch_vccnz f_dV0
    ds_read_b128 v[32:35], v2 offset:0
    ds_read_b64_tr_b16 v[36:37], v6 offset:0
    ds_read_b64_tr_b16 v[38:39], v6 offset:256
    ds_read_b128 v[40:43], v3 offset:0
    ds_read_b64_tr_b16 v[44:45], v6 offset:1024
    ds_read_b64_tr_b16 v[46:47], v6 offset:1280
    ds_read_b128 v[48:51], v2 offset:2048
    ds_read_b64_tr_b16 v[52:53], v6 offset:2048
    ds_read_b64_tr_b16 v[54:55], v6 offset:2304
    ds_read_b128 v[56:59], v3 offset:2048
    ds_read_b64_tr_b16 v[60:61], v6 offset:3072
    ds_read_b64_tr_b16 v[62:63], v6 offset:3328
    s_waitcnt lgkmcnt(9)
    v_mfma_f32_32x32x16_bf16 v[16:31], v[32:35], v[36:39], 0
    s_waitcnt lgkmcnt(6)
    ds_read_b128 v[64:67], v2 offset:4096
    ds_read_b64_tr_b16 v[68:69], v6 offset:4096
    ds_read_b64_tr_b16 v[70:71], v6 offset:4352
    ds_read_b128 v[72:75], v3 offset:4096
    ds_read_b64_tr_b16 v[76:77], v6 offset:5120
    ds_read_b64_tr_b16 v[78:79], v6 offset:5376
    v_mfma_f32_32x32x16_bf16 v[16:31], v[40:43], v[44:47], v[16:31]
    s_waitcnt lgkmcnt(9)
    v_mfma_f32_32x32x16_bf16 v[16:31], v[48:51], v[52:55], v[16:31]
    s_waitcnt lgkmcnt(6)
    ds_read_b128 v[32:35], v2 offset:6144
    ds_read_b64_tr_b16 v[36:37], v6 offset:6144
    ds_read_b64_tr_b16 v[38:39], v6 offset:6400
    ds_read_b128 v[40:43], v3 offset:6144
    ds_read_b64_tr_b16 v[44:45], v6 offset:7168
    ds_read_b64_tr_b16 v[46:47], v6 offset:7424
    v_mfma_f32_32x32x16_bf16 v[16:31], v[56:59], v[60:63], v[16:31]
    s_waitcnt lgkmcnt(9)
    v_mfma_f32_32x32x16_bf16 v[16:31], v[64:67], v[68:71], v[16:31]
    s_waitcnt lgkmcnt(6)
    ds_read_b128 v[48:51], v2 offset:8192
    ds_read_b64_tr_b16 v[52:53], v6 offset:8192
    ds_read_b64_tr_b16 v[54:55], v6 offset:8448
    ds_read_b128 v[56:59], v3 offset:8192
    ds_read_b64_tr_b16 v[60:61], v6 offset:9216
    ds_read_b64_tr_b16 v[62:63], v6 offset:9472
    v_mfma_f32_32x32x16_bf16 v[16:31], v[72:75], v[76:79], v[16:31]
    s_waitcnt lgkmcnt(9)
    v_mfma_f32_32x32x16_bf16 v[16:31], v[32:35], v[36:39], v[16:31]
    s_waitcnt lgkmcnt(6)
    ds_read_b32 v8, v4
    ds_read_b128 v[64:67], v2 offset:10240
    ds_read_b64_tr_b16 v[68:69], v6 offset:10240
    ds_read_b64_tr_b16 v[70:71], v6 offset:10496
    ds_read_b128 v[72:75], v3 offset:10240
    ds_read_b64_tr_b16 v[76:77], v6 offset:11264
    ds_read_b64_tr_b16 v[78:79], v6 offset:11520
    v_mfma_f32_32x32x16_bf16 v[16:31], v[40:43], v[44:47], v[16:31]
    s_waitcnt lgkmcnt(6)
    v_cmp_gt_i32 vcc, 4, v8
    s_cbranch_vccz f_dV4_ok
f_dV4:
    ds_read_b32 v8, v4
    s_waitcnt lgkmcnt(0)
    v_cmp_gt_i32 vcc, 4, v8
    s_cbranch_vccnz f_dV4
f_dV4_ok:
    v_mfma_f32_32x32x16_bf16 v[16:31], v[48:51], v[52:55], v[16:31]
    ds_read_b128 v[32:35], v2 offset:12288
    ds_read_b64_tr_b16 v[36:37], v6 offset:12288
    ds_read_b64_tr_b16 v[38:39], v6 offset:12544
    ds_read_b128 v[40:43], v3 offset:12288
    ds_read_b64_tr_b16 v[44:45], v6 offset:13312
    ds_read_b64_tr_b16 v[46:47], v6 offset:13568
    v_mfma_f32_32x32x16_bf16 v[16:31], v[56:59], v[60:63], v[16:31]
    s_waitcnt lgkmcnt(9)
    v_mfma_f32_32x32x16_bf16 v[16:31], v[64:67], v[68:71], v[16:31]
    s_waitcnt lgkmcnt(6)
    ds_read_b128 v[48:51], v2 offset:14336
    ds_read_b64_tr_b16 v[52:53], v6 offset:14336
    ds_read_b64_tr_b16 v[54:55], v6 offset:14592
    ds_read_b128 v[56:59], v3 offset:14336
    ds_read_b64_tr_b16 v[60:61], v6 offset:15360
    ds_read_b64_tr_b16 v[62:63], v6 offset:15616
    v_mfma_f32_32x32x16_bf16 v[16:31], v[72:75], v[76:79], v[16:31]
    s_waitcnt lgkmcnt(9)
    v_mfma_f32_32x32x16_bf16 v[16:31], v[32:35], v[36:39], v[16:31]
    s_waitcnt lgkmcnt(6)
    ds_read_b128 v[64:67], v2 offset:16384
    ds_read_b64_tr_b16 v[68:69], v6 offset:16384
    ds_read_b64_tr_b16 v[70:71], v6 offset:16640
    ds_read_b128 v[72:75], v3 offset:16384
    ds_read_b64_tr_b16 v[76:77], v6 offset:17408
    ds_read_b64_tr_b16 v[78:79], v6 offset:17664
    v_mfma_f32_32x32x16_bf16 v[16:31], v[40:43], v[44:47], v[16:31]
    s_waitcnt lgkmcnt(9)
    v_mfma_f32_32x32x16_bf16 v[16:31], v[48:51], v[52:55], v[16:31]
    s_waitcnt lgkmcnt(6)
    ds_read_b128 v[32:35], v2 offset:18432
    ds_read_b64_tr_b16 v[36:37], v6 offset:18432
    ds_read_b64_tr_b16 v[38:39], v6 offset:18688
    ds_read_b128 v[40:43], v3 offset:18432
    ds_read_b64_tr_b16 v[44:45], v6 offset:19456
    ds_read_b64_tr_b16 v[46:47], v6 offset:19712
    v_mfma_f32_32x32x16_bf16 v[16:31], v[56:59], v[60:63], v[16:31]
    s_waitcnt lgkmcnt(9)
    v_mfma_f32_32x32x16_bf16 v[16:31], v[64:67], v[68:71], v[16:31]
    s_waitcnt lgkmcnt(6)
    ds_read_b128 v[48:51], v2 offset:20480
    ds_read_b64_tr_b16 v[52:53], v6 offset:20480
    ds_read_b64_tr_b16 v[54:55], v6 offset:20736
    ds_read_b128 v[56:59], v3 offset:20480
    ds_read_b64_tr_b16 v[60:61], v6 offset:21504
    ds_read_b64_tr_b16 v[62:63], v6 offset:21760
    v_mfma_f32_32x32x16_bf16 v[16:31], v[72:75], v[76:79], v[16:31]
    s_waitcnt lgkmcnt(9)
    v_mfma_f32_32x32x16_bf16 v[16:31], v[32:35], v[36:39], v[16:31]
    s_waitcnt lgkmcnt(6)
    ds_read_b32 v8, v4
    ds_read_b128 v[64:67], v2 offset:22528
    ds_read_b64_tr_b16 v[68:69], v6 offset:22528
    ds_read_b64_tr_b16 v[70:71], v6 offset:22784
    ds_read_b128 v[72:75], v3 offset:22528
    ds_read_b64_tr_b16 v[76:77], v6 offset:23552
    ds_read_b64_tr_b16 v[78:79], v6 offset:23808
    v_mfma_f32_32x32x16_bf16 v[16:31], v[40:43], v[44:47], v[16:31]
    s_waitcnt lgkmcnt(6)
    v_cmp_gt_i32 vcc, 6, v8
    s_cbranch_vccz f_dV10_ok
f_dV10:
    ds_read_b32 v8, v4
    s_waitcnt lgkmcnt(0)
    v_cmp_gt_i32 vcc, 6, v8
    s_cbranch_vccnz f_dV10
f_dV10_ok:
    v_mfma_f32_32x32x16_bf16 v[16:31], v[48:51], v[52:55], v[16:31]
    ds_read_b128 v[32:35], v2 offset:24576
    ds_read_b64_tr_b16 v[36:37], v6 offset:24576
    ds_read_b64_tr_b16 v[38:39], v6 offset:24832
    ds_read_b128 v[40:43], v3 offset:24576
    ds_read_b64_tr_b16 v[44:45], v6 offset:25600
    ds_read_b64_tr_b16 v[46:47], v6 offset:25856
    v_mfma_f32_32x32x16_bf16 v[16:31], v[56:59], v[60:63], v[16:31]
    s_waitcnt lgkmcnt(9)
    v_mfma_f32_32x32x16_bf16 v[16:31], v[64:67], v[68:71], v[16:31]
    s_waitcnt lgkmcnt(6)
    ds_read_b128 v[48:51], v2 offset:26624
    ds_read_b64_tr_b16 v[52:53], v6 offset:26624
    ds_read_b64_tr_b16 v[54:55], v6 offset:26880
    ds_read_b128 v[56:59], v3 offset:26624
    ds_read_b64_tr_b16 v[60:61], v6 offset:27648
    ds_read_b64_tr_b16 v[62:63], v6 offset:27904
    v_mfma_f32_32x32x16_bf16 v[16:31], v[72:75], v[76:79], v[16:31]
    s_waitcnt lgkmcnt(9)
    v_mfma_f32_32x32x16_bf16 v[16:31], v[32:35], v[36:39], v[16:31]
    s_waitcnt lgkmcnt(6)
    ds_read_b128 v[64:67], v2 offset:28672
    ds_read_b64_tr_b16 v[68:69], v6 offset:28672
    ds_read_b64_tr_b16 v[70:71], v6 offset:28928
    ds_read_b128 v[72:75], v3 offset:28672
    ds_read_b64_tr_b16 v[76:77], v6 offset:29696
    ds_read_b64_tr_b16 v[78:79], v6 offset:29952
    v_mfma_f32_32x32x16_bf16 v[16:31], v[40:43], v[44:47], v[16:31]
    s_waitcnt lgkmcnt(9)
    v_mfma_f32_32x32x16_bf16 v[16:31], v[48:51], v[52:55], v[16:31]
    s_waitcnt lgkmcnt(6)
    ds_read_b128 v[32:35], v2 offset:30720
    ds_read_b64_tr_b16 v[36:37], v6 offset:30720
    ds_read_b64_tr_b16 v[38:39], v6 offset:30976
    ds_read_b128 v[40:43], v3 offset:30720
    ds_read_b64_tr_b16 v[44:45], v6 offset:31744
    ds_read_b64_tr_b16 v[46:47], v6 offset:32000
    v_mfma_f32_32x32x16_bf16 v[16:31], v[56:59], v[60:63], v[16:31]
    s_waitcnt lgkmcnt(9)
    v_mfma_f32_32x32x16_bf16 v[16:31], v[64:67], v[68:71], v[16:31]
    s_waitcnt lgkmcnt(6)
    ds_read_b128 v[48:51], v2 offset:32768
    ds_read_b64_tr_b16 v[52:53], v6 offset:32768
    ds_read_b64_tr_b16 v[54:55], v6 offset:33024
    ds_read_b128 v[56:59], v3 offset:32768
    ds_read_b64_tr_b16 v[60:61], v6 offset:33792
    ds_read_b64_tr_b16 v[62:63], v6 offset:34048
    v_mfma_f32_32x32x16_bf16 v[16:31], v[72:75], v[76:79], v[16:31]
    s_waitcnt lgkmcnt(9)
    v_mfma_f32_32x32x16_bf16 v[16:31], v[32:35], v[36:39], v[16:31]
    s_waitcnt lgkmcnt(6)
    ds_read_b128 v[64:67], v2 offset:34816
    ds_read_b64_tr_b16 v[68:69], v6 offset:34816
    ds_read_b64_tr_b16 v[70:71], v6 offset:35072
    ds_read_b128 v[72:75], v3 offset:34816
    ds_read_b64_tr_b16 v[76:77], v6 offset:35840
    ds_read_b64_tr_b16 v[78:79], v6 offset:36096
    v_mfma_f32_32x32x16_bf16 v[16:31], v[40:43], v[44:47], v[16:31]
    s_waitcnt lgkmcnt(9)
    v_mfma_f32_32x32x16_bf16 v[16:31], v[48:51], v[52:55], v[16:31]
    s_waitcnt lgkmcnt(6)
    v_mfma_f32_32x32x16_bf16 v[16:31], v[56:59], v[60:63], v[16:31]
    s_waitcnt lgkmcnt(3)
    v_mfma_f32_32x32x16_bf16 v[16:31], v[64:67], v[68:71], v[16:31]
    s_waitcnt lgkmcnt(0)
    v_mfma_f32_32x32x16_bf16 v[16:31], v[72:75], v[76:79], v[16:31]
    v_mov_b32 v8, 159832
    v_mov_b32 v9, 1
    ds_write_b32 v8, v9
    s_add_u32 s54, s54, 1
    s_mov_b32 exec_lo, 0x3ffff
    s_mov_b32 exec_hi, 0x3ffff
    s_nop 5
    v_cvt_pk_bf16_f32 v80, v16, v17
    v_cvt_pk_bf16_f32 v81, v18, v19
    v_cvt_pk_bf16_f32 v82, v20, v21
    v_cvt_pk_bf16_f32 v83, v22, v23
    v_cvt_pk_bf16_f32 v84, v24, v25
    v_cvt_pk_bf16_f32 v85, v26, v27
    v_cvt_pk_bf16_f32 v86, v28, v29
    v_cvt_pk_bf16_f32 v87, v30, v31
    s_mov_b32 exec_lo, 0xfffff
    s_mov_b32 exec_hi, 0xfffff
    buffer_store_dwordx4 v[80:83], v14, s[8:11], s64 offen offset:1152 sc1
    buffer_store_dwordx4 v[84:87], v14, s[8:11], s64 offen offset:1792 sc1
    buffer_store_dwordx4 v[80:83], v14, s[8:11], s63 offen offset:1152 sc1
    buffer_store_dwordx4 v[84:87], v14, s[8:11], s63 offen offset:1792 sc1
    s_mov_b64 exec, -1
f_dP:
    s_waitcnt vmcnt(0)
    s_lshl_b32 s65, s57, 7
    s_lshl_b32 s66, s58, 3
    s_add_u32 s65, s65, s66
    s_add_u32 s65, s65, 65536
    v_lshlrev_b32 v8, 12, v1
    v_mov_b32 v10, s54
    v_mov_b32 v11, s55
    s_mov_b64 exec, 255
    buffer_atomic_swap_x2 v[10:11], v8, s[8:11], s65 offen sc1
    s_mov_b64 exec, -1
    s_branch f_dS
f_cF:
    s_bfe_u32 s76, s58, 0x10001
    s_add_u32 s76, s76, 16
    s_waitcnt lgkmcnt(0)
    s_add_u32 s54, s54, 1
    s_mov_b32 s74, s76
    v_mov_b32 v110, v2
    v_mov_b32 v108, v4
    s_setprio 2
    v_and_b32 v4, 3, v1
    v_bfe_u32 v5, v1, 2, 1
    v_lshl_add_u32 v4, v5, 3, v4
    v_bfe_u32 v5, v1, 3, 1
    v_lshl_add_u32 v4, v5, 2, v4
    s_lshl_b32 s3, s74, 4
    v_add_u32 v4, s3, v4
    s_cmp_eq_u32 s74, 0
    s_cselect_b32 s6, 0x10000, 0
    s_mov_b32 s7, s6
    v_mov_b32 v5, 288
    v_cndmask_b32 v4, v4, v5, s[6:7]
    s_or_b32 s6, s6, 0xffff
    s_mov_b32 s7, s6
    v_mov_b32 v5, 144
    v_cndmask_b32 v5, v5, 0, s[6:7]
    v_lshrrev_b32 v6, 5, v1
    v_lshlrev_b32 v6, 3, v6
    s_lshl_b32 s3, s67, 6
    v_add_u32 v6, s3, v6
    v_mad_u32_u24 v5, v4, v6, v5
    s_mov_b32 s6, 7456541
    s_mov_b32 s7, 987991609
    v_mul_hi_u32 v8, v5, s6
    v_mul_u32_u24 v8, 576, v8
    v_sub_u32 v8, v5, v8
    v_cvt_f32_u32 v8, v8
    v_mul_f32 v8, s7, v8
    v_cos_f32 v16, v8
    v_add_u32 v5, v5, v4
    v_mul_hi_u32 v8, v5, s6
    v_mul_u32_u24 v8, 576, v8
    v_sub_u32 v8, v5, v8
    v_cvt_f32_u32 v8, v8
    v_mul_f32 v8, s7, v8
    v_cos_f32 v17, v8
    v_mul_u32_u24 v6, 15, v4
    v_add_u32 v5, v5, v6
    v_mul_hi_u32 v8, v5, s6
    v_mul_u32_u24 v8, 576, v8
    v_sub_u32 v8, v5, v8
    v_cvt_f32_u32 v8, v8
    v_mul_f32 v8, s7, v8
    v_cos_f32 v24, v8
    v_add_u32 v5, v5, v4
    v_mul_hi_u32 v8, v5, s6
    v_mul_u32_u24 v8, 576, v8
    v_sub_u32 v8, v5, v8
    v_cvt_f32_u32 v8, v8
    v_mul_f32 v8, s7, v8
    v_cos_f32 v25, v8
    v_mul_hi_u32 v8, v4, s6
    v_mul_u32_u24 v8, 576, v8
    v_sub_u32 v8, v4, v8
    v_cvt_f32_u32 v8, v8
    v_mul_f32 v8, s7, v8
    v_cos_f32 v7, v8
    v_lshlrev_b32 v6, 4, v4
    v_add_f32 v7, v7, v7
    v_mul_hi_u32 v8, v6, s6
    v_mul_u32_u24 v8, 576, v8
    v_sub_u32 v8, v6, v8
    v_cvt_f32_u32 v8, v8
    v_mul_f32 v8, s7, v8
    v_cos_f32 v6, v8
    v_fma_f32 v18, v7, v17, -v16
    v_fma_f32 v26, v7, v25, -v24
    v_fma_f32 v19, v7, v18, -v17
    v_fma_f32 v27, v7, v26, -v25
    v_fma_f32 v20, v7, v19, -v18
    v_fma_f32 v28, v7, v27, -v26
    v_fma_f32 v21, v7, v20, -v19
    v_fma_f32 v29, v7, v28, -v27
    v_fma_f32 v22, v7, v21, -v20
    v_fma_f32 v30, v7, v29, -v28
    v_fma_f32 v23, v7, v22, -v21
    v_fma_f32 v31, v7, v30, -v29
    v_add_f32 v6, v6, v6
    v_lshlrev_b32 v4, 31, v4
    v_or_b32 v4, 1.0, v4
    v_xor_b32 v8, 32, v110
    v_cvt_pk_bf16_f32 v72, v16, v17
    v_cvt_pk_bf16_f32 v73, v18, v19
    v_cvt_pk_bf16_f32 v74, v20, v21
    v_cvt_pk_bf16_f32 v75, v22, v23
    v_fma_f32 v16, v6, v24, -v16
    v_fma_f32 v17, v6, v25, -v17
    v_fma_f32 v18, v6, v26, -v18
    v_fma_f32 v19, v6, v27, -v19
    v_fma_f32 v20, v6, v28, -v20
    v_fma_f32 v21, v6, v29, -v21
    v_fma_f32 v22, v6, v30, -v22
    v_fma_f32 v23, v6, v31, -v23
    v_cvt_pk_bf16_f32 v76, v24, v25
    v_cvt_pk_bf16_f32 v77, v26, v27
    v_cvt_pk_bf16_f32 v78, v28, v29
    v_cvt_pk_bf16_f32 v79, v30, v31
    v_fma_f32 v24, v6, v16, -v24
    v_fma_f32 v25, v6, v17, -v25
    v_fma_f32 v26, v6, v18, -v26
    v_fma_f32 v27, v6, v19, -v27
    v_fma_f32 v28, v6, v20, -v28
    v_fma_f32 v29, v6, v21, -v29
    v_fma_f32 v30, v6, v22, -v30
    v_fma_f32 v31, v6, v23, -v31
    v_cvt_pk_bf16_f32 v80, v16, v17
    v_cvt_pk_bf16_f32 v81, v18, v19
    v_cvt_pk_bf16_f32 v82, v20, v21
    v_cvt_pk_bf16_f32 v83, v22, v23
    v_fma_f32 v16, v6, v24, -v16
    v_fma_f32 v17, v6, v25, -v17
    v_fma_f32 v18, v6, v26, -v18
    v_fma_f32 v19, v6, v27, -v19
    v_fma_f32 v20, v6, v28, -v20
    v_fma_f32 v21, v6, v29, -v21
    v_fma_f32 v22, v6, v30, -v22
    v_fma_f32 v23, v6, v31, -v23
    v_cvt_pk_bf16_f32 v84, v24, v25
    v_cvt_pk_bf16_f32 v85, v26, v27
    v_cvt_pk_bf16_f32 v86, v28, v29
    v_cvt_pk_bf16_f32 v87, v30, v31
    v_fma_f32 v24, v6, v16, -v24
    v_fma_f32 v25, v6, v17, -v25
    v_fma_f32 v26, v6, v18, -v26
    v_fma_f32 v27, v6, v19, -v27
    v_fma_f32 v28, v6, v20, -v28
    v_fma_f32 v29, v6, v21, -v29
    v_fma_f32 v30, v6, v22, -v30
    v_fma_f32 v31, v6, v23, -v31
    v_cvt_pk_bf16_f32 v88, v16, v17
    v_cvt_pk_bf16_f32 v89, v18, v19
    v_cvt_pk_bf16_f32 v90, v20, v21
    v_cvt_pk_bf16_f32 v91, v22, v23
    v_fma_f32 v16, v6, v24, -v16
    v_fma_f32 v17, v6, v25, -v17
    v_fma_f32 v18, v6, v26, -v18
    v_fma_f32 v19, v6, v27, -v19
    v_fma_f32 v20, v6, v28, -v20
    v_fma_f32 v21, v6, v29, -v21
    v_fma_f32 v22, v6, v30, -v22
    v_fma_f32 v23, v6, v31, -v23
    v_cvt_pk_bf16_f32 v92, v24, v25
    v_cvt_pk_bf16_f32 v93, v26, v27
    v_cvt_pk_bf16_f32 v94, v28, v29
    v_cvt_pk_bf16_f32 v95, v30, v31
    v_fma_f32 v24, v6, v16, -v24
    v_fma_f32 v25, v6, v17, -v25
    v_fma_f32 v26, v6, v18, -v26
    v_fma_f32 v27, v6, v19, -v27
    v_fma_f32 v28, v6, v20, -v28
    v_fma_f32 v29, v6, v21, -v29
    v_fma_f32 v30, v6, v22, -v30
    v_fma_f32 v31, v6, v23, -v31
    v_cvt_pk_bf16_f32 v96, v16, v17
    v_cvt_pk_bf16_f32 v97, v18, v19
    v_cvt_pk_bf16_f32 v98, v20, v21
    v_cvt_pk_bf16_f32 v99, v22, v23
    v_fma_f32 v16, v6, v24, -v16
    v_fma_f32 v17, v6, v25, -v17
    v_fma_f32 v18, v6, v26, -v18
    v_fma_f32 v19, v6, v27, -v19
    v_fma_f32 v20, v6, v28, -v20
    v_fma_f32 v21, v6, v29, -v21
    v_fma_f32 v22, v6, v30, -v22
    v_fma_f32 v23, v6, v31, -v23
    v_cvt_pk_bf16_f32 v100, v24, v25
    v_cvt_pk_bf16_f32 v101, v26, v27
    v_cvt_pk_bf16_f32 v102, v28, v29
    v_cvt_pk_bf16_f32 v103, v30, v31
    v_fma_f32 v24, v6, v16, -v24
    v_fma_f32 v25, v6, v17, -v25
    v_fma_f32 v26, v6, v18, -v26
    v_fma_f32 v27, v6, v19, -v27
    v_fma_f32 v28, v6, v20, -v28
    v_fma_f32 v29, v6, v21, -v29
    v_fma_f32 v30, v6, v22, -v30
    v_fma_f32 v31, v6, v23, -v31
    v_cvt_pk_bf16_f32 v104, v16, v17
    v_cvt_pk_bf16_f32 v105, v18, v19
    v_cvt_pk_bf16_f32 v106, v20, v21
    v_cvt_pk_bf16_f32 v107, v22, v23
    v_fma_f32 v16, v6, v24, -v16
    v_fma_f32 v17, v6, v25, -v17
    v_fma_f32 v18, v6, v26, -v18
    v_fma_f32 v19, v6, v27, -v19
    v_fma_f32 v20, v6, v28, -v20
    v_fma_f32 v21, v6, v29, -v21
    v_fma_f32 v22, v6, v30, -v22
    v_fma_f32 v23, v6, v31, -v23
    v_cvt_pk_bf16_f32 v132, v24, v25
    v_cvt_pk_bf16_f32 v133, v26, v27
    v_cvt_pk_bf16_f32 v134, v28, v29
    v_cvt_pk_bf16_f32 v135, v30, v31
    v_fma_f32 v24, v6, v16, -v24
    v_fma_f32 v25, v6, v17, -v25
    v_fma_f32 v26, v6, v18, -v26
    v_fma_f32 v27, v6, v19, -v27
    v_fma_f32 v28, v6, v20, -v28
    v_fma_f32 v29, v6, v21, -v29
    v_fma_f32 v30, v6, v22, -v30
    v_fma_f32 v31, v6, v23, -v31
    v_cvt_pk_bf16_f32 v136, v16, v17
    v_cvt_pk_bf16_f32 v137, v18, v19
    v_cvt_pk_bf16_f32 v138, v20, v21
    v_cvt_pk_bf16_f32 v139, v22, v23
    v_fma_f32 v16, v6, v24, -v16
    v_fma_f32 v17, v6, v25, -v17
    v_fma_f32 v18, v6, v26, -v18
    v_fma_f32 v19, v6, v27, -v19
    v_fma_f32 v20, v6, v28, -v20
    v_fma_f32 v21, v6, v29, -v21
    v_fma_f32 v22, v6, v30, -v22
    v_fma_f32 v23, v6, v31, -v23
    v_cvt_pk_bf16_f32 v140, v24, v25
    v_cvt_pk_bf16_f32 v141, v26, v27
    v_cvt_pk_bf16_f32 v142, v28, v29
    v_cvt_pk_bf16_f32 v143, v30, v31
    v_fma_f32 v24, v6, v16, -v24
    v_fma_f32 v25, v6, v17, -v25
    v_fma_f32 v26, v6, v18, -v26
    v_fma_f32 v27, v6, v19, -v27
    v_fma_f32 v28, v6, v20, -v28
    v_fma_f32 v29, v6, v21, -v29
    v_fma_f32 v30, v6, v22, -v30
    v_fma_f32 v31, v6, v23, -v31
    v_cvt_pk_bf16_f32 v144, v16, v17
    v_cvt_pk_bf16_f32 v145, v18, v19
    v_cvt_pk_bf16_f32 v146, v20, v21
    v_cvt_pk_bf16_f32 v147, v22, v23
    v_fma_f32 v16, v6, v24, -v16
    v_fma_f32 v17, v6, v25, -v17
    v_fma_f32 v18, v6, v26, -v18
    v_fma_f32 v19, v6, v27, -v19
    v_fma_f32 v20, v6, v28, -v20
    v_fma_f32 v21, v6, v29, -v21
    v_fma_f32 v22, v6, v30, -v22
    v_fma_f32 v23, v6, v31, -v23
    v_cvt_pk_bf16_f32 v148, v24, v25
    v_cvt_pk_bf16_f32 v149, v26, v27
    v_cvt_pk_bf16_f32 v150, v28, v29
    v_cvt_pk_bf16_f32 v151, v30, v31
    v_fma_f32 v24, v6, v16, -v24
    v_fma_f32 v25, v6, v17, -v25
    v_fma_f32 v26, v6, v18, -v26
    v_fma_f32 v27, v6, v19, -v27
    v_fma_f32 v28, v6, v20, -v28
    v_fma_f32 v29, v6, v21, -v29
    v_fma_f32 v30, v6, v22, -v30
    v_fma_f32 v31, v6, v23, -v31
    v_cvt_pk_bf16_f32 v152, v16, v17
    v_cvt_pk_bf16_f32 v153, v18, v19
    v_cvt_pk_bf16_f32 v154, v20, v21
    v_cvt_pk_bf16_f32 v155, v22, v23
    v_fma_f32 v16, v6, v24, -v16
    v_fma_f32 v17, v6, v25, -v17
    v_fma_f32 v18, v6, v26, -v18
    v_fma_f32 v19, v6, v27, -v19
    v_fma_f32 v20, v6, v28, -v20
    v_fma_f32 v21, v6, v29, -v21
    v_fma_f32 v22, v6, v30, -v22
    v_fma_f32 v23, v6, v31, -v23
    v_cvt_pk_bf16_f32 v156, v24, v25
    v_cvt_pk_bf16_f32 v157, v26, v27
    v_cvt_pk_bf16_f32 v158, v28, v29
    v_cvt_pk_bf16_f32 v159, v30, v31
    v_fma_f32 v24, v6, v16, -v24
    v_fma_f32 v25, v6, v17, -v25
    v_fma_f32 v26, v6, v18, -v26
    v_fma_f32 v27, v6, v19, -v27
    v_fma_f32 v28, v6, v20, -v28
    v_fma_f32 v29, v6, v21, -v29
    v_fma_f32 v30, v6, v22, -v30
    v_fma_f32 v31, v6, v23, -v31
    v_cvt_pk_bf16_f32 v160, v16, v17
    v_cvt_pk_bf16_f32 v161, v18, v19
    v_cvt_pk_bf16_f32 v162, v20, v21
    v_cvt_pk_bf16_f32 v163, v22, v23
    v_cvt_pk_bf16_f32 v164, v24, v25
    v_cvt_pk_bf16_f32 v165, v26, v27
    v_cvt_pk_bf16_f32 v166, v28, v29
    v_cvt_pk_bf16_f32 v167, v30, v31
    s_branch f_k1
f_k1_z:
    s_sleep 1
f_k1:
    ds_read_b32 v5, v108
    s_waitcnt lgkmcnt(0)
    v_cmp_gt_i32 vcc, 3, v5
    s_cbranch_vccnz f_k1_z
    ds_read_b128 v[48:51], v110 offset:0
    ds_read_b128 v[52:55], v8 offset:0
    ds_read_b128 v[56:59], v110 offset:2048
    ds_read_b128 v[60:63], v8 offset:2048
    ds_read_b128 v[64:67], v110 offset:4096
    ds_read_b128 v[68:71], v8 offset:4096
    ds_read_b128 v[116:119], v110 offset:6144
    ds_read_b128 v[120:123], v8 offset:6144
    ds_read_b128 v[124:127], v110 offset:8192
    s_waitcnt lgkmcnt(8)
    v_mfma_f32_32x32x16_bf16 v[16:31], v[48:51], v[72:75], 0
    ds_read_b128 v[48:51], v8 offset:8192
    s_waitcnt lgkmcnt(8)
    v_mfma_f32_32x32x16_bf16 v[16:31], v[52:55], v[76:79], v[16:31]
    ds_read_b128 v[52:55], v110 offset:10240
    s_waitcnt lgkmcnt(8)
    v_mfma_f32_32x32x16_bf16 v[16:31], v[56:59], v[80:83], v[16:31]
    ds_read_b128 v[56:59], v8 offset:10240
    s_waitcnt lgkmcnt(8)
    v_mfma_f32_32x32x16_bf16 v[16:31], v[60:63], v[84:87], v[16:31]
    ds_read_b32 v5, v108
    ds_read_b128 v[60:63], v110 offset:12288
    s_waitcnt lgkmcnt(9)
    v_mfma_f32_32x32x16_bf16 v[16:31], v[64:67], v[88:91], v[16:31]
    ds_read_b128 v[64:67], v8 offset:12288
    s_waitcnt lgkmcnt(9)
    v_mfma_f32_32x32x16_bf16 v[16:31], v[68:71], v[92:95], v[16:31]
    ds_read_b128 v[68:71], v110 offset:14336
    s_waitcnt lgkmcnt(9)
    v_mfma_f32_32x32x16_bf16 v[16:31], v[116:119], v[96:99], v[16:31]
    ds_read_b128 v[116:119], v8 offset:14336
    s_waitcnt lgkmcnt(9)
    v_mfma_f32_32x32x16_bf16 v[16:31], v[120:123], v[100:103], v[16:31]
    ds_read_b128 v[120:123], v110 offset:16384
    s_waitcnt lgkmcnt(9)
    v_mfma_f32_32x32x16_bf16 v[16:31], v[124:127], v[104:107], v[16:31]
    ds_read_b128 v[124:127], v8 offset:16384
    s_waitcnt lgkmcnt(9)
    v_mfma_f32_32x32x16_bf16 v[16:31], v[48:51], v[132:135], v[16:31]
    s_waitcnt lgkmcnt(8)
    v_mfma_f32_32x32x16_bf16 v[16:31], v[52:55], v[136:139], v[16:31]
    s_waitcnt lgkmcnt(7)
    v_mfma_f32_32x32x16_bf16 v[16:31], v[56:59], v[140:143], v[16:31]
    s_waitcnt lgkmcnt(5)
    v_mfma_f32_32x32x16_bf16 v[16:31], v[60:63], v[144:147], v[16:31]
    s_waitcnt lgkmcnt(4)
    v_mfma_f32_32x32x16_bf16 v[16:31], v[64:67], v[148:151], v[16:31]
    s_waitcnt lgkmcnt(3)
    v_mfma_f32_32x32x16_bf16 v[16:31], v[68:71], v[152:155], v[16:31]
    v_cmp_gt_i32 vcc, 6, v5
    s_cbranch_vccz f_k2_ok
f_k2:
    ds_read_b32 v5, v108
    s_waitcnt lgkmcnt(0)
    v_cmp_gt_i32 vcc, 6, v5
    s_cbranch_vccnz f_k2
f_k2_ok:
    ds_read_b128 v[48:51], v110 offset:18432
    ds_read_b128 v[52:55], v8 offset:18432
    ds_read_b128 v[56:59], v110 offset:20480
    ds_read_b128 v[60:63], v8 offset:20480
    ds_read_b128 v[64:67], v110 offset:22528
    ds_read_b128 v[68:71], v8 offset:22528
    s_waitcnt lgkmcnt(8)
    v_mfma_f32_32x32x16_bf16 v[16:31], v[116:119], v[156:159], v[16:31]
    ds_read_b128 v[116:119], v110 offset:24576
    s_waitcnt lgkmcnt(8)
    v_mfma_f32_32x32x16_bf16 v[16:31], v[120:123], v[160:163], v[16:31]
    ds_read_b128 v[120:123], v8 offset:24576
    s_waitcnt lgkmcnt(8)
    v_mfma_f32_32x32x16_bf16 v[16:31], v[124:127], v[164:167], v[16:31]
    ds_read_b128 v[124:127], v110 offset:26624
    s_waitcnt lgkmcnt(8)
    v_mfma_f32_32x32x16_bf16 v[32:47], v[48:51], v[72:75], 0
    ds_read_b128 v[48:51], v8 offset:26624
    ds_read_b128 v[72:75], v110 offset:28672
    s_waitcnt lgkmcnt(9)
    v_mfma_f32_32x32x16_bf16 v[32:47], v[52:55], v[76:79], v[32:47]
    ds_read_b128 v[52:55], v8 offset:28672
    ds_read_b128 v[76:79], v110 offset:30720
    s_waitcnt lgkmcnt(10)
    v_mfma_f32_32x32x16_bf16 v[32:47], v[56:59], v[80:83], v[32:47]
    ds_read_b128 v[56:59], v8 offset:30720
    ds_read_b128 v[80:83], v110 offset:32768
    s_waitcnt lgkmcnt(11)
    v_mfma_f32_32x32x16_bf16 v[32:47], v[60:63], v[84:87], v[32:47]
    ds_read_b128 v[60:63], v8 offset:32768
    ds_read_b128 v[84:87], v110 offset:34816
    s_waitcnt lgkmcnt(12)
    v_mfma_f32_32x32x16_bf16 v[32:47], v[64:67], v[88:91], v[32:47]
    ds_read_b128 v[64:67], v8 offset:34816
    s_waitcnt lgkmcnt(12)
    v_mfma_f32_32x32x16_bf16 v[32:47], v[68:71], v[92:95], v[32:47]
    s_waitcnt lgkmcnt(11)
    v_mfma_f32_32x32x16_bf16 v[32:47], v[116:119], v[96:99], v[32:47]
    s_waitcnt lgkmcnt(10)
    v_mfma_f32_32x32x16_bf16 v[32:47], v[120:123], v[100:103], v[32:47]
    s_waitcnt lgkmcnt(9)
    v_mfma_f32_32x32x16_bf16 v[32:47], v[124:127], v[104:107], v[32:47]
    s_waitcnt lgkmcnt(8)
    v_mfma_f32_32x32x16_bf16 v[32:47], v[48:51], v[132:135], v[32:47]
    s_waitcnt lgkmcnt(7)
    v_mfma_f32_32x32x16_bf16 v[32:47], v[72:75], v[136:139], v[32:47]
    s_waitcnt lgkmcnt(6)
    v_mfma_f32_32x32x16_bf16 v[32:47], v[52:55], v[140:143], v[32:47]
    s_waitcnt lgkmcnt(5)
    v_mfma_f32_32x32x16_bf16 v[32:47], v[76:79], v[144:147], v[32:47]
    s_getpc_b64 s[4:5]
f_krf:
    s_add_u32 s4, s4, rf_table-f_krf
    s_addc_u32 s5, s5, 0
    v_lshlrev_b32 v5, 4, v1
    global_load_dwordx4 v[132:135], v5, s[4:5] offset:0
    global_load_dwordx4 v[136:139], v5, s[4:5] offset:1024
    global_load_dwordx4 v[140:143], v5, s[4:5] offset:2048
    global_load_dwordx4 v[144:147], v5, s[4:5] offset:3072
    s_waitcnt lgkmcnt(4)
    v_mfma_f32_32x32x16_bf16 v[32:47], v[56:59], v[148:151], v[32:47]
    s_waitcnt lgkmcnt(3)
    v_mfma_f32_32x32x16_bf16 v[32:47], v[80:83], v[152:155], v[32:47]
    s_waitcnt lgkmcnt(2)
    v_mfma_f32_32x32x16_bf16 v[32:47], v[60:63], v[156:159], v[32:47]
    s_waitcnt lgkmcnt(1)
    v_mfma_f32_32x32x16_bf16 v[32:47], v[84:87], v[160:163], v[32:47]
    s_waitcnt lgkmcnt(0)
    v_mfma_f32_32x32x16_bf16 v[32:47], v[64:67], v[164:167], v[32:47]
    s_nop 11
    v_fmac_f32 v16, v4, v32
    v_fmac_f32 v17, v4, v33
    v_fmac_f32 v18, v4, v34
    v_fmac_f32 v19, v4, v35
    v_fmac_f32 v20, v4, v36
    v_fmac_f32 v21, v4, v37
    v_fmac_f32 v22, v4, v38
    v_fmac_f32 v23, v4, v39
    v_fmac_f32 v24, v4, v40
    v_fmac_f32 v25, v4, v41
    v_fmac_f32 v26, v4, v42
    v_fmac_f32 v27, v4, v43
    v_fmac_f32 v28, v4, v44
    v_fmac_f32 v29, v4, v45
    v_fmac_f32 v30, v4, v46
    v_fmac_f32 v31, v4, v47
    v_cvt_pk_bf16_f32 v116, v16, v17
    v_cvt_pk_bf16_f32 v117, v18, v19
    v_cvt_pk_bf16_f32 v118, v20, v21
    v_cvt_pk_bf16_f32 v119, v22, v23
    v_cvt_pk_bf16_f32 v120, v24, v25
    v_cvt_pk_bf16_f32 v121, v26, v27
    v_cvt_pk_bf16_f32 v122, v28, v29
    v_cvt_pk_bf16_f32 v123, v30, v31
    s_waitcnt vmcnt(0)
    v_mfma_f32_32x32x16_bf16 v[32:47], v[116:119], v[132:135], 0
    v_mfma_f32_32x32x16_bf16 v[64:79], v[116:119], v[140:143], 0
    v_mfma_f32_32x32x16_bf16 v[32:47], v[120:123], v[136:139], v[32:47]
    v_mfma_f32_32x32x16_bf16 v[64:79], v[120:123], v[144:147], v[64:79]
    s_cmp_eq_u32 s74, 0
    s_cselect_b32 s6, -1, 0
    s_mov_b32 s7, 0
    s_nop 8
    v_cvt_pk_bf16_f32 v130, v40, v72
    v_cndmask_b32 v40, v40, 0, s[6:7]
    v_cndmask_b32 v72, v72, 0, s[6:7]
    v_add_f32 v80, v32, v72
    v_add_f32 v81, v33, v73
    v_add_f32 v82, v34, v74
    v_add_f32 v83, v35, v75
    v_add_f32 v84, v36, v76
    v_add_f32 v85, v37, v77
    v_add_f32 v86, v38, v78
    v_add_f32 v87, v39, v79
    v_cvt_pk_bf16_f32 v48, v80, v81
    v_cvt_pk_bf16_f32 v49, v82, v83
    v_cvt_pk_bf16_f32 v50, v84, v85
    v_cvt_pk_bf16_f32 v51, v86, v87
    v_sub_f32 v80, v64, v40
    v_sub_f32 v81, v65, v41
    v_sub_f32 v82, v66, v42
    v_sub_f32 v83, v67, v43
    v_sub_f32 v84, v68, v44
    v_sub_f32 v85, v69, v45
    v_sub_f32 v86, v70, v46
    v_sub_f32 v87, v71, v47
    v_cvt_pk_bf16_f32 v52, v80, v81
    v_cvt_pk_bf16_f32 v53, v82, v83
    v_cvt_pk_bf16_f32 v54, v84, v85
    v_cvt_pk_bf16_f32 v55, v86, v87
    v_sub_f32 v80, v32, v72
    v_sub_f32 v81, v33, v73
    v_sub_f32 v82, v34, v74
    v_sub_f32 v83, v35, v75
    v_sub_f32 v84, v36, v76
    v_sub_f32 v85, v37, v77
    v_sub_f32 v86, v38, v78
    v_sub_f32 v87, v39, v79
    v_cvt_pk_bf16_f32 v56, v87, v86
    v_cvt_pk_bf16_f32 v57, v85, v84
    v_cvt_pk_bf16_f32 v58, v83, v82
    v_cvt_pk_bf16_f32 v59, v81, v80
    v_add_f32 v80, v64, v40
    v_add_f32 v81, v65, v41
    v_add_f32 v82, v66, v42
    v_add_f32 v83, v67, v43
    v_add_f32 v84, v68, v44
    v_add_f32 v85, v69, v45
    v_add_f32 v86, v70, v46
    v_add_f32 v87, v71, v47
    v_cvt_pk_bf16_f32 v60, v87, v86
    v_cvt_pk_bf16_f32 v61, v85, v84
    v_cvt_pk_bf16_f32 v62, v83, v82
    v_cvt_pk_bf16_f32 v63, v81, v80
    s_setprio 3
f_dS:
    s_add_u32 s6, s56, 0
    s_lshl_b32 s3, s6, 6
    v_add_u32 v8, s3, v1
    v_mul_u32_u24 v9, 7282, v8
    v_lshrrev_b32 v9, 16, v9
    v_mul_u32_u24 v10, 9, v9
    v_sub_u32 v8, v8, v10
    v_lshlrev_b32 v8, 4, v8
    v_and_b32 v10, 1, v9
    v_bfe_u32 v11, v9, 1, 2
    v_and_b32 v9, 56, v9
    v_lshl_add_u32 v9, v10, 2, v9
    v_add_u32 v9, v9, v11
    s_movk_i32 s3, 1280
    v_mad_u32_u24 v106, v9, s3, v8
    s_movk_i32 s3, 1152
    v_lshrrev_b32 v10, 4, v9
    v_lshl_add_u32 v10, v10, 1, v9
    v_mad_u32_u24 v100, v10, s3, v8
    v_lshrrev_b32 v10, 1, v9
    v_lshl_add_u32 v10, v10, 4, v9
    v_add_u32 v10, 16, v10
    v_mad_u32_u24 v103, v10, s3, v8
    v_add_u32 v9, 0, v1
    v_mul_u32_u24 v10, 7282, v9
    v_lshrrev_b32 v10, 16, v10
    v_lshlrev_b32 v9, 4, v9
    s_mov_b32 s3, 73584
    v_mad_u32_u24 v161, v10, s3, v9
    s_add_u32 s6, s56, 4
    s_lshl_b32 s3, s6, 6
    v_add_u32 v8, s3, v1
    v_mul_u32_u24 v9, 7282, v8
    v_lshrrev_b32 v9, 16, v9
    v_mul_u32_u24 v10, 9, v9
    v_sub_u32 v8, v8, v10
    v_lshlrev_b32 v8, 4, v8
    v_and_b32 v10, 1, v9
    v_bfe_u32 v11, v9, 1, 2
    v_and_b32 v9, 56, v9
    v_lshl_add_u32 v9, v10, 2, v9
    v_add_u32 v9, v9, v11
    s_movk_i32 s3, 1280
    v_mad_u32_u24 v107, v9, s3, v8
    s_movk_i32 s3, 1152
    v_lshrrev_b32 v10, 4, v9
    v_lshl_add_u32 v10, v10, 1, v9
    v_mad_u32_u24 v101, v10, s3, v8
    v_lshrrev_b32 v10, 1, v9
    v_lshl_add_u32 v10, v10, 4, v9
    v_add_u32 v10, 16, v10
    v_mad_u32_u24 v104, v10, s3, v8
    v_add_u32 v9, 64, v1
    v_mul_u32_u24 v10, 7282, v9
    v_lshrrev_b32 v10, 16, v10
    v_lshlrev_b32 v9, 4, v9
    s_mov_b32 s3, 73584
    v_mad_u32_u24 v162, v10, s3, v9
    s_add_u32 s6, s56, 8
    s_lshl_b32 s3, s6, 6
    v_add_u32 v8, s3, v1
    v_mul_u32_u24 v9, 7282, v8
    v_lshrrev_b32 v9, 16, v9
    v_mul_u32_u24 v10, 9, v9
    v_sub_u32 v8, v8, v10
    v_lshlrev_b32 v8, 4, v8
    v_and_b32 v10, 1, v9
    v_bfe_u32 v11, v9, 1, 2
    v_and_b32 v9, 56, v9
    v_lshl_add_u32 v9, v10, 2, v9
    v_add_u32 v9, v9, v11
    s_movk_i32 s3, 1280
    v_mad_u32_u24 v108, v9, s3, v8
    s_movk_i32 s3, 1152
    v_lshrrev_b32 v10, 4, v9
    v_lshl_add_u32 v10, v10, 1, v9
    v_mad_u32_u24 v102, v10, s3, v8
    v_lshrrev_b32 v10, 1, v9
    v_lshl_add_u32 v10, v10, 4, v9
    v_add_u32 v10, 16, v10
    v_mad_u32_u24 v105, v10, s3, v8
    v_add_u32 v9, 128, v1
    v_mul_u32_u24 v10, 7282, v9
    v_lshrrev_b32 v10, 16, v10
    v_lshlrev_b32 v9, 4, v9
    s_mov_b32 s3, 73584
    v_mad_u32_u24 v163, v10, s3, v9
    v_lshlrev_b32 v156, 4, v1
    v_lshrrev_b32 v10, 3, v1
    v_xor_b32 v11, v10, v1
    v_and_b32 v11, 7, v11
    v_lshlrev_b32 v11, 4, v11
    v_lshl_add_u32 v11, v10, 7, v11
    s_lshl_b32 s3, s56, 12
    s_add_u32 s3, s3, 81920
    v_add_u32 v109, s3, v11
    v_and_b32 v9, 7, v1
    v_lshlrev_b32 v160, 3, v9
    v_lshl_add_u32 v118, v10, 7, v160
    v_mul_u32_u24 v10, 163840, v10
    v_lshl_add_u32 v110, v9, 4, v10
    v_lshlrev_b32 v9, 2, v9
    v_add_u32 v113, 159760, v9
    v_and_b32 v9, 12, v9
    v_add_u32 v114, 159856, v9
    v_add_u32 v115, 159808, v9
    s_lshl_b32 s3, s56, 2
    s_add_u32 s6, s3, 159808
    v_mov_b32 v116, s6
    s_add_u32 s6, s3, 159744
    v_mov_b32 v117, s6
    v_and_b32 v8, 15, v1
    v_lshrrev_b32 v10, 4, v1
    v_lshlrev_b32 v9, 2, v8
    v_lshl_add_u32 v159, v10, 9, v9
    s_lshl_b32 s3, s56, 6
    s_add_u32 s3, s3, 160000
    v_add_u32 v112, s3, v9
    s_and_b32 s3, s56, 1
    s_lshl_b32 s3, s3, 22
    v_lshlrev_b32 v9, 18, v8
    v_lshl_add_u32 v9, v10, 4, v9
    v_add_u32 v111, s3, v9
    s_mul_i32 s3, s56, 2304
    s_add_u32 s3, s3, 57344
    v_mul_u32_u24 v9, 144, v8
    v_lshl_add_u32 v9, v10, 3, v9
    v_add_u32 v164, s3, v9
    v_add_u32 v165, s3, v156
    v_bfe_u32 v11, v1, 2, 2
    v_lshl_add_u32 v10, v10, 2, v11
    v_mul_u32_u24 v10, 288, v10
    v_and_b32 v11, 3, v1
    v_lshl_add_u32 v157, v11, 3, v10
    v_add_u32 v158, 110592, v157
    v_bfe_u32 v9, v1, 2, 2
    v_add_u32 v9, s57, v9
    v_and_b32 v9, 31, v9
    v_lshlrev_b32 v9, 7, v9
    v_and_b32 v10, 3, v1
    v_lshl_add_u32 v9, v10, 3, v9
    s_and_b32 s62, s57, 7
    s_lshl_b32 s62, s62, 12
    s_add_u32 s62, s62, 65536
    s_mov_b32 s66, 0
    s_mov_b64 exec, 65535
f_m2:
    v_mov_b32 v32, 0
    v_mov_b32 v33, 0
    buffer_atomic_or_x2 v[32:33], v9, s[8:11], s62 offen sc0 sc1
    s_add_u32 s66, s66, 1
    s_waitcnt vmcnt(0) lgkmcnt(0)
    v_cmp_ne_u64 vcc, s[54:55], v[32:33]
    s_cbranch_vccz f_m2_ok
    s_sleep 1
    s_cmp_lt_u32 s66, 20000
    s_cbranch_scc1 f_m2
f_m2_ok:
    s_mov_b64 exec, -1
    v_mov_b32 v9, 159792
    v_mov_b32 v10, 1
    ds_write_b32 v9, v10
    v_lshrrev_b32 v14, 2, v1
    v_lshlrev_b32 v14, 7, v14
    v_and_b32 v10, 3, v1
    v_lshl_add_u32 v14, v10, 3, v14
    v_and_b32 v9, 15, v1
    v_min_u32 v9, 8, v9
    v_lshlrev_b32 v9, 2, v9
    v_add_u32 v9, 159760, v9
    s_mul_i32 s59, s57, 4864
    s_lshl_b32 s60, s56, 12
    s_add_u32 m0, s60, 110592
    s_add_u32 s59, s59, s60
    s_add_u32 s59, s59, 327680
    v_mov_b32 v6, 1
    v_mov_b32 v4, 159796
f_kv1:
    ds_read_b32 v10, v9
    s_waitcnt lgkmcnt(0)
    v_cmp_gt_i32 vcc, 1, v10
    s_cbranch_vccnz f_kv1
    buffer_load_dwordx4 v156, s[8:11], s59 offen offset:0 sc1 lds
    buffer_load_dwordx4 v156, s[8:11], s59 offen offset:1024 sc1 lds
    buffer_load_dwordx4 v156, s[8:11], s59 offen offset:2048 sc1 lds
    buffer_load_dwordx4 v156, s[8:11], s59 offen offset:3072 sc1 lds
    s_waitcnt vmcnt(0)
    ds_write_b32 v117, v6
    s_mov_b32 s66, 0
f_m3:
    buffer_load_dwordx2 v[32:33], v14, s[8:11], s62 offen offset:0 sc1
    buffer_load_dwordx2 v[34:35], v14, s[8:11], s62 offen offset:2048 sc1
    s_add_u32 s66, s66, 1
    s_waitcnt vmcnt(0) lgkmcnt(0)
    v_cmp_ne_u64 vcc, s[54:55], v[32:33]
    v_cmp_ne_u64 s[6:7], s[54:55], v[34:35]
    s_nop 0
    s_or_b64 vcc, vcc, s[6:7]
    s_cbranch_vccz f_m3_ok
    s_sleep 2
    s_cmp_lt_u32 s66, 20000
    s_cbranch_scc1 f_m3
f_m3_ok:
f_m4:
    ds_write_b32 v4, v6
f_h1:
    s_branch f_h2
f_h2_z:
    s_sleep 1
f_h2:
    ds_read_b32 v9, v4
    s_waitcnt lgkmcnt(0)
    v_cmp_gt_i32 vcc, 1, v9
    s_cbranch_vccnz f_h2_z
    s_branch f_h2a
f_h2a_z:
    s_sleep 1
f_h2a:
    ds_read_b32 v9, v113
    s_waitcnt lgkmcnt(0)
    v_cmp_gt_i32 vcc, 2, v9
    s_cbranch_vccnz f_h2a_z
    s_add_u32 m0, s60, 126976
    s_add_u32 s3, s59, 16384
    buffer_load_dwordx4 v156, s[8:11], s3 offen offset:0 sc1 lds
    buffer_load_dwordx4 v156, s[8:11], s3 offen offset:1024 sc1 lds
    buffer_load_dwordx4 v156, s[8:11], s3 offen offset:2048 sc1 lds
    buffer_load_dwordx4 v156, s[8:11], s3 offen offset:3072 sc1 lds
    v_mov_b32 v7, 2
    s_waitcnt vmcnt(0)
    ds_write_b32 v117, v7
    s_branch f_h2b
f_h2b_z:
    s_sleep 1
f_h2b:
    ds_read_b32 v9, v113
    s_waitcnt lgkmcnt(0)
    v_cmp_gt_i32 vcc, 3, v9
    s_cbranch_vccnz f_h2b_z
    s_add_u32 m0, s60, 143360
    s_add_u32 s3, s59, 32768
    buffer_load_dwordx4 v156, s[8:11], s3 offen offset:0 sc1 lds
    buffer_load_dwordx4 v156, s[8:11], s3 offen offset:1024 sc1 lds
    buffer_load_dwordx4 v156, s[8:11], s3 offen offset:2048 sc1 lds
    s_waitcnt vmcnt(2)
    buffer_load_dwordx4 v156, s[8:11], s3 offen offset:3072 sc1 lds
    s_add_u32 m0, s60, 0
    s_add_u32 s3, s59, 48640
    s_waitcnt vmcnt(2)
    buffer_load_dwordx4 v156, s[8:11], s3 offen offset:0 sc1 lds
    s_waitcnt vmcnt(2)
    buffer_load_dwordx4 v156, s[8:11], s3 offen offset:1024 sc1 lds
    s_waitcnt vmcnt(2)
    buffer_load_dwordx4 v156, s[8:11], s3 offen offset:2048 sc1 lds
    s_waitcnt vmcnt(2)
    buffer_load_dwordx4 v156, s[8:11], s3 offen offset:3072 sc1 lds
    s_add_u32 m0, s60, 16384
    s_add_u32 s3, s59, 65024
    s_waitcnt vmcnt(2)
    buffer_load_dwordx4 v156, s[8:11], s3 offen offset:0 sc1 lds
    s_waitcnt vmcnt(2)
    buffer_load_dwordx4 v156, s[8:11], s3 offen offset:1024 sc1 lds
    s_waitcnt vmcnt(2)
    v_mov_b32 v7, 3
    ds_write_b32 v117, v7
    buffer_load_dwordx4 v156, s[8:11], s3 offen offset:2048 sc1 lds
    s_waitcnt vmcnt(2)
    buffer_load_dwordx4 v156, s[8:11], s3 offen offset:3072 sc1 lds
    s_add_u32 m0, s60, 32768
    s_add_u32 s3, s59, 81408
    s_waitcnt vmcnt(2)
    buffer_load_dwordx4 v156, s[8:11], s3 offen offset:0 sc1 lds
    s_waitcnt vmcnt(2)
    buffer_load_dwordx4 v156, s[8:11], s3 offen offset:1024 sc1 lds
    s_waitcnt vmcnt(2)
    buffer_load_dwordx4 v156, s[8:11], s3 offen offset:2048 sc1 lds
    s_waitcnt vmcnt(2)
    buffer_load_dwordx4 v156, s[8:11], s3 offen offset:3072 sc1 lds
    s_add_u32 m0, s60, 49152
    s_add_u32 s3, s59, 97792
    s_waitcnt vmcnt(2)
    buffer_load_dwordx4 v156, s[8:11], s3 offen offset:0 sc1 lds
    s_waitcnt vmcnt(2)
    buffer_load_dwordx4 v156, s[8:11], s3 offen offset:1024 sc1 lds
    s_waitcnt vmcnt(2)
    v_mov_b32 v7, 4
    ds_write_b32 v117, v7
    buffer_load_dwordx4 v156, s[8:11], s3 offen offset:2048 sc1 lds
    s_waitcnt vmcnt(2)
    buffer_load_dwordx4 v156, s[8:11], s3 offen offset:3072 sc1 lds
    s_add_u32 m0, s60, 65536
    s_add_u32 s3, s59, 114176
    s_waitcnt vmcnt(2)
    buffer_load_dwordx4 v156, s[8:11], s3 offen offset:0 sc1 lds
    s_waitcnt vmcnt(2)
    buffer_load_dwordx4 v156, s[8:11], s3 offen offset:1024 sc1 lds
    s_waitcnt vmcnt(2)
    buffer_load_dwordx4 v156, s[8:11], s3 offen offset:2048 sc1 lds
    s_waitcnt vmcnt(2)
    buffer_load_dwordx4 v156, s[8:11], s3 offen offset:3072 sc1 lds
    s_and_b32 s71, s58, 1
    s_lshl_b32 s71, s71, 5
    s_add_u32 s71, s71, s57
    s_mul_i32 s71, s71, 1280
    s_add_u32 s71, s71, 3407872
    s_lshr_b32 s72, s58, 1
    s_lshl_b32 s72, s72, 7
    s_sub_u32 s3, 1152, s72
    s_cmp_lt_u32 s56, 2
    s_cselect_b32 s72, s72, s3
    s_add_u32 s72, s72, s71
    s_bitcmp1_b32 s56, 0
    s_cselect_b32 s3, 81920, 0
    s_add_u32 s72, s72, s3
    s_branch f_x3
f_x3_z:
    s_sleep 2
f_x3:
    ds_read_b32 v9, v114
    s_waitcnt lgkmcnt(0)
    v_cmp_gt_i32 vcc, 1, v9
    s_cbranch_vccnz f_x3_z
    ds_read_b128 v[32:35], v109 offset:0
    ds_read_b128 v[36:39], v109 offset:1024
    ds_read_b128 v[40:43], v109 offset:2048
    ds_read_b128 v[44:47], v109 offset:3072
    s_waitcnt lgkmcnt(0)
    ds_write_b32 v116, v6
    s_branch f_x4
f_x4_z:
    s_sleep 1
f_x4:
    ds_read_b32 v9, v115
    s_waitcnt lgkmcnt(0)
    v_cmp_gt_i32 vcc, 1, v9
    s_cbranch_vccnz f_x4_z
    s_add_u32 m0, s60, 81920
    s_add_u32 s3, s59, 130560
    s_waitcnt vmcnt(2)
    buffer_load_dwordx4 v156, s[8:11], s3 offen offset:0 sc1 lds
    s_waitcnt vmcnt(2)
    buffer_load_dwordx4 v156, s[8:11], s3 offen offset:1024 sc1 lds
    s_waitcnt vmcnt(2)
    buffer_load_dwordx4 v156, s[8:11], s3 offen offset:2048 sc1 lds
    s_waitcnt vmcnt(2)
    buffer_load_dwordx4 v156, s[8:11], s3 offen offset:3072 sc1 lds
    s_cmp_ge_u32 s56, 3
    s_cbranch_scc1 f_h3
    s_add_u32 m0, s60, 98304
    s_add_u32 s3, s59, 146944
    s_waitcnt vmcnt(2)
    buffer_load_dwordx4 v156, s[8:11], s3 offen offset:0 sc1 lds
    s_waitcnt vmcnt(2)
    buffer_load_dwordx4 v156, s[8:11], s3 offen offset:1024 sc1 lds
    s_waitcnt vmcnt(2)
    buffer_load_dwordx4 v156, s[8:11], s3 offen offset:2048 sc1 lds
    s_waitcnt vmcnt(2)
    buffer_load_dwordx4 v156, s[8:11], s3 offen offset:3072 sc1 lds
f_h3:
    v_mov_b32 v7, 5
    s_waitcnt vmcnt(0)
    ds_write_b32 v117, v7
    buffer_store_dwordx4 v[32:35], v110, s[8:11], s72 offen sc1
    s_add_u32 s72, s72, 1310720
    buffer_store_dwordx4 v[36:39], v110, s[8:11], s72 offen sc1
    s_add_u32 s72, s72, 1310720
    buffer_store_dwordx4 v[40:43], v110, s[8:11], s72 offen sc1
    s_add_u32 s72, s72, 1310720
    buffer_store_dwordx4 v[44:47], v110, s[8:11], s72 offen sc1
    s_cmp_lg_u32 s56, 0
    s_cbranch_scc1 f_h3b
    s_lshr_b32 s3, s58, 1
    s_cmp_lg_u32 s3, 0
    s_cbranch_scc1 f_h3c
    v_lshlrev_b32 v11, 2, v1
    v_add_u32 v13, 160384, v11
    ds_read_b32 v13, v13
    s_lshl_b32 s64, s70, 7
    s_add_u32 s64, s64, 266240
    s_mov_b32 exec_hi, 0
    s_waitcnt lgkmcnt(0)
    buffer_store_dword v13, v11, s[8:11], s64 offen sc1
    s_mov_b32 exec_hi, -1
f_h3c:
    v_and_b32 v9, 31, v1
    v_mul_u32_u24 v10, 163840, v9
    s_cmp_ge_u32 s58, 4
    s_cbranch_scc1 f_h3a
    s_cmp_ge_u32 s58, 2
    s_cbranch_scc1 f_h3b
    v_lshlrev_b32 v9, 2, v9
    v_add_u32 v9, 160256, v9
    ds_read_b32 v9, v9
    s_add_u32 s3, s71, 81920
    s_mov_b32 exec_hi, 0
    s_waitcnt lgkmcnt(0)
    buffer_store_short v9, v10, s[8:11], s71 offen offset:702 sc1
    buffer_store_short_d16_hi v9, v10, s[8:11], s3 offen offset:702 sc1
    s_mov_b32 exec_hi, -1
    s_branch f_h3b
f_h3a:
    v_lshrrev_b32 v11, 5, v1
    v_lshlrev_b32 v11, 4, v11
    v_sub_u32 v9, v10, v11
    v_add_u32 v10, v10, v11
    v_add_u32 v9, 16, v9
    s_lshl_b32 s3, s76, 5
    s_add_u32 s72, s71, s3
    s_sub_u32 s73, s71, s3
    s_add_u32 s73, s73, 1248
    buffer_store_dwordx4 v[48:51], v10, s[8:11], s72 offen sc1
    s_add_u32 s72, s72, 81920
    buffer_store_dwordx4 v[52:55], v10, s[8:11], s72 offen sc1
    buffer_store_dwordx4 v[56:59], v9, s[8:11], s73 offen sc1
    s_add_u32 s73, s73, 81920
    buffer_store_dwordx4 v[60:63], v9, s[8:11], s73 offen sc1
f_h3b:
    s_waitcnt vmcnt(0)
    v_mov_b32 v9, 159800
    v_mov_b32 v10, 1
    s_mov_b64 exec, 1
    ds_add_rtn_u32 v10, v9, v10
    s_waitcnt lgkmcnt(0)
    v_readfirstlane_b32 s65, v10
    s_mov_b64 exec, -1
    s_cmp_lg_u32 s65, 3
    s_cbranch_scc1 f_h5
    s_lshl_b32 s65, s57, 7
    s_lshl_b32 s66, s58, 3
    s_add_u32 s65, s65, s66
    s_add_u32 s65, s65, 131072
    v_lshlrev_b32 v9, 12, v1
    v_mov_b32 v10, s54
    v_mov_b32 v11, s55
    s_mov_b64 exec, 255
    buffer_store_dwordx2 v[10:11], v9, s[8:11], s65 offen sc1
    s_mov_b64 exec, -1
f_h5:
    s_mov_b32 s12, s34
    s_mov_b32 s13, s35
    s_mov_b32 s14, 663552
    s_mov_b32 s15, 0x20000
    s_mov_b32 s40, s18
    s_mov_b32 s41, s19
    s_mov_b32 s42, 8388608
    s_mov_b32 s43, 0x20000
    s_mov_b32 s44, s20
    s_mov_b32 s45, s21
    s_mov_b32 s46, 8388608
    s_mov_b32 s47, 0x20000
    s_mov_b32 s48, s38
    s_mov_b32 s49, s39
    s_mov_b32 s50, 2359296
    s_mov_b32 s51, 0x20000
    s_lshr_b32 s3, s2, 3
    s_lshl_b32 s3, s3, 2
    s_add_u32 s3, s3, s56
    s_mul_i32 s3, s3, 5248
    v_lshlrev_b32 v9, 3, v156
    s_mov_b32 exec_hi, 0x1ff
    buffer_load_dword v14, v9, s[12:15], s3 offen
    s_mov_b32 exec_hi, -1
    s_lshr_b32 s70, s56, 1
    s_lshl_b32 s70, s70, 5
    s_add_u32 s70, s70, s57
    s_mul_i32 s71, s58, 144
    s_lshl_b32 s61, s56, 10
    s_lshl_b32 s59, s70, 12
    buffer_load_dwordx4 v[36:39], v111, s[40:43], s59 offen offset:0
    buffer_load_dwordx4 v[40:43], v111, s[40:43], s59 offen offset:64
    buffer_load_dwordx4 v[44:47], v111, s[44:47], s59 offen offset:0
    buffer_load_dwordx4 v[48:51], v111, s[44:47], s59 offen offset:64
    s_branch f_t1
f_t1_z:
    s_sleep 32
f_t1:
    ds_read_b32 v9, v113
    s_waitcnt lgkmcnt(0)
    v_cmp_gt_i32 vcc, 4, v9
    s_cbranch_vccnz f_t1_z
    s_add_u32 s60, s58, 0
    s_and_b32 s60, s60, 7
    s_mul_i32 s60, s60, 82944
    s_add_u32 s60, s60, s71
    s_add_u32 m0, s61, 110592
    s_waitcnt vmcnt(2)
    buffer_load_dwordx4 v100, s[12:15], s60 offen  lds
    s_add_u32 m0, s61, 114688
    s_waitcnt vmcnt(2)
    buffer_load_dwordx4 v101, s[12:15], s60 offen  lds
    s_cmp_lg_u32 s56, 0
    s_cbranch_scc1 f_ds1
    s_add_u32 m0, s61, 118784
    s_waitcnt vmcnt(2)
    buffer_load_dwordx4 v102, s[12:15], s60 offen  lds
f_ds1:
    s_add_u32 s60, s58, 1
    s_and_b32 s60, s60, 7
    s_mul_i32 s60, s60, 82944
    s_add_u32 s60, s60, s71
    s_add_u32 m0, s61, 119808
    s_waitcnt vmcnt(2)
    buffer_load_dwordx4 v100, s[12:15], s60 offen  lds
    s_add_u32 m0, s61, 123904
    s_waitcnt vmcnt(2)
    buffer_load_dwordx4 v101, s[12:15], s60 offen  lds
    s_cmp_lg_u32 s56, 0
    s_cbranch_scc1 f_ds2
    s_add_u32 m0, s61, 128000
    s_waitcnt vmcnt(2)
    buffer_load_dwordx4 v102, s[12:15], s60 offen  lds
f_ds2:
    s_add_u32 s60, s58, 2
    s_and_b32 s60, s60, 7
    s_mul_i32 s60, s60, 82944
    s_add_u32 s60, s60, s71
    s_add_u32 m0, s61, 129024
    s_waitcnt vmcnt(2)
    buffer_load_dwordx4 v100, s[12:15], s60 offen  lds
    s_add_u32 m0, s61, 133120
    s_waitcnt vmcnt(2)
    buffer_load_dwordx4 v101, s[12:15], s60 offen  lds
    s_cmp_lg_u32 s56, 0
    s_cbranch_scc1 f_ds3
    s_add_u32 m0, s61, 137216
    s_waitcnt vmcnt(2)
    buffer_load_dwordx4 v102, s[12:15], s60 offen  lds
f_ds3:
    s_add_u32 s60, s58, 3
    s_and_b32 s60, s60, 7
    s_mul_i32 s60, s60, 82944
    s_add_u32 s60, s60, s71
    s_add_u32 m0, s61, 138240
    s_waitcnt vmcnt(2)
    buffer_load_dwordx4 v100, s[12:15], s60 offen  lds
    s_add_u32 m0, s61, 142336
    s_waitcnt vmcnt(2)
    buffer_load_dwordx4 v101, s[12:15], s60 offen  lds
    s_cmp_lg_u32 s56, 0
    s_cbranch_scc1 f_ds4
    s_add_u32 m0, s61, 146432
    s_waitcnt vmcnt(2)
    buffer_load_dwordx4 v102, s[12:15], s60 offen  lds
f_ds4:
    s_add_u32 s60, s58, 4
    s_and_b32 s60, s60, 7
    s_mul_i32 s60, s60, 82944
    s_add_u32 s60, s60, s71
    s_add_u32 m0, s61, 147456
    s_waitcnt vmcnt(2)
    buffer_load_dwordx4 v100, s[12:15], s60 offen  lds
    s_add_u32 m0, s61, 151552
    s_waitcnt vmcnt(2)
    buffer_load_dwordx4 v101, s[12:15], s60 offen  lds
    s_cmp_lg_u32 s56, 0
    s_cbranch_scc1 f_ds5
    s_add_u32 m0, s61, 155648
    s_waitcnt vmcnt(2)
    buffer_load_dwordx4 v102, s[12:15], s60 offen  lds
f_ds5:
    s_branch f_t3
f_t3_z:
    s_sleep 32
f_t3:
    ds_read_b32 v9, v113
    s_waitcnt lgkmcnt(0)
    v_cmp_gt_i32 vcc, 5, v9
    s_cbranch_vccnz f_t3_z
    s_add_u32 s60, s58, 5
    s_and_b32 s60, s60, 7
    s_mul_i32 s60, s60, 82944
    s_add_u32 s60, s60, s71
    s_add_u32 m0, s61, 0
    s_waitcnt vmcnt(2)
    buffer_load_dwordx4 v100, s[12:15], s60 offen  lds
    s_add_u32 m0, s61, 4096
    s_waitcnt vmcnt(2)
    buffer_load_dwordx4 v101, s[12:15], s60 offen  lds
    s_cmp_lg_u32 s56, 0
    s_cbranch_scc1 f_ds6
    s_add_u32 m0, s61, 8192
    s_waitcnt vmcnt(2)
    buffer_load_dwordx4 v102, s[12:15], s60 offen  lds
f_ds6:
    s_add_u32 s60, s58, 6
    s_and_b32 s60, s60, 7
    s_mul_i32 s60, s60, 82944
    s_add_u32 s60, s60, s71
    s_add_u32 m0, s61, 9216
    s_waitcnt vmcnt(2)
    buffer_load_dwordx4 v100, s[12:15], s60 offen  lds
    s_add_u32 m0, s61, 13312
    s_waitcnt vmcnt(2)
    buffer_load_dwordx4 v101, s[12:15], s60 offen  lds
    s_cmp_lg_u32 s56, 0
    s_cbranch_scc1 f_ds7
    s_add_u32 m0, s61, 17408
    s_waitcnt vmcnt(2)
    buffer_load_dwordx4 v102, s[12:15], s60 offen  lds
f_ds7:
    s_add_u32 s60, s58, 7
    s_and_b32 s60, s60, 7
    s_mul_i32 s60, s60, 82944
    s_add_u32 s60, s60, s71
    s_add_u32 m0, s61, 18432
    s_waitcnt vmcnt(2)
    buffer_load_dwordx4 v100, s[12:15], s60 offen  lds
    s_add_u32 m0, s61, 22528
    s_waitcnt vmcnt(2)
    buffer_load_dwordx4 v101, s[12:15], s60 offen  lds
    s_cmp_lg_u32 s56, 0
    s_cbranch_scc1 f_ds8
    s_add_u32 m0, s61, 26624
    s_waitcnt vmcnt(2)
    buffer_load_dwordx4 v102, s[12:15], s60 offen  lds
f_ds8:
    v_mov_b32 v4, 159824
    s_cmp_lg_u32 s56, 3
    s_cbranch_scc1 f_t6_x
    s_and_b32 s62, s57, 7
    s_lshl_b32 s62, s62, 12
    s_add_u32 s62, s62, 131072
    s_mov_b32 s66, 0
f_t6:
    buffer_load_dwordx2 v[52:53], v118, s[8:11], s62 offen offset:0 sc1
    buffer_load_dwordx2 v[54:55], v118, s[8:11], s62 offen offset:1024 sc1
    buffer_load_dwordx2 v[56:57], v118, s[8:11], s62 offen offset:2048 sc1
    buffer_load_dwordx2 v[58:59], v118, s[8:11], s62 offen offset:3072 sc1
    s_add_u32 s66, s66, 1
    s_waitcnt vmcnt(0) lgkmcnt(0)
    v_cmp_ne_u64 vcc, s[54:55], v[52:53]
    v_cmp_ne_u64 s[6:7], s[54:55], v[54:55]
    s_nop 0
    s_or_b64 vcc, vcc, s[6:7]
    v_cmp_ne_u64 s[6:7], s[54:55], v[56:57]
    s_nop 0
    s_or_b64 vcc, vcc, s[6:7]
    v_cmp_ne_u64 s[6:7], s[54:55], v[58:59]
    s_nop 0
    s_or_b64 vcc, vcc, s[6:7]
    s_cbranch_vccz f_t6_ok
    s_sleep 8
    s_cmp_lt_u32 s66, 20000
    s_cbranch_scc1 f_t6
f_t6_ok:
    v_and_b32 v9, 31, v1
    v_lshrrev_b32 v10, 5, v1
    v_lshlrev_b32 v9, 2, v9
    v_lshl_add_u32 v9, v10, 12, v9
    s_lshl_b32 s3, s57, 7
    s_add_u32 s3, s3, 266240
    buffer_load_dword v10, v9, s[8:11], s3 offen sc1
    v_lshrrev_b32 v9, 2, v156
    v_add_u32 v9, 160000, v9
    s_waitcnt vmcnt(0)
    ds_write_b32 v9, v10
    ds_write_b32 v4, v6
    s_cmp_lg_u32 s2, 0
    s_cbranch_scc1 f_t6_x
    v_mov_b32 v9, 0
    v_mov_b32 v10, s54
    v_mov_b32 v11, s55
    s_mov_b64 exec, 1
    buffer_store_dwordx2 v[10:11], v9, s[8:11], 0 offen
    s_mov_b64 exec, -1
f_t6_x:
    s_branch f_t7
f_t7_z:
    s_sleep 8
f_t7:
    ds_read_b32 v9, v113
    s_waitcnt lgkmcnt(0)
    v_cmp_gt_i32 vcc, 6, v9
    s_cbranch_vccnz f_t7_z
    s_mov_b32 s60, s71
    s_add_u32 m0, s61, 27648
    s_waitcnt vmcnt(2)
    buffer_load_dwordx4 v103, s[12:15], s60 offen  lds
    s_add_u32 m0, s61, 31744
    s_waitcnt vmcnt(2)
    buffer_load_dwordx4 v104, s[12:15], s60 offen  lds
    s_cmp_lg_u32 s56, 0
    s_cbranch_scc1 f_ds9
    s_add_u32 m0, s61, 35840
    s_waitcnt vmcnt(2)
    buffer_load_dwordx4 v105, s[12:15], s60 offen  lds
f_ds9:
    s_mul_i32 s60, s57, 163840
    s_add_u32 s60, s60, 3407872
    s_add_u32 s60, s60, s71
    s_cmp_ge_u32 s58, 4
    s_cselect_b32 s3, 126, 0
    s_add_u32 s60, s60, s3
    s_branch f_t8
f_t8_z:
    s_sleep 4
f_t8:
    ds_read_b32 v9, v4
    s_waitcnt lgkmcnt(0)
    v_cmp_gt_i32 vcc, 1, v9
    s_cbranch_vccnz f_t8_z
    ds_read_b32 v15, v112
    s_add_u32 m0, s61, 36864
    s_waitcnt vmcnt(2)
    buffer_load_dwordx4 v106, s[8:11], s60 offen sc1 lds
    s_add_u32 m0, s61, 40960
    s_waitcnt vmcnt(2)
    buffer_load_dwordx4 v107, s[8:11], s60 offen sc1 lds
    s_cmp_lg_u32 s56, 0
    s_cbranch_scc1 f_ds10
    s_add_u32 m0, s61, 45056
    s_waitcnt vmcnt(2)
    buffer_load_dwordx4 v108, s[8:11], s60 offen sc1 lds
f_ds10:
    s_add_u32 s60, s60, 81920
    s_add_u32 m0, s61, 46080
    s_waitcnt vmcnt(2)
    buffer_load_dwordx4 v106, s[8:11], s60 offen sc1 lds
    s_add_u32 m0, s61, 50176
    s_waitcnt vmcnt(2)
    buffer_load_dwordx4 v107, s[8:11], s60 offen sc1 lds
    s_cmp_lg_u32 s56, 0
    s_cbranch_scc1 f_ds11
    s_add_u32 m0, s61, 54272
    s_waitcnt vmcnt(2)
    buffer_load_dwordx4 v108, s[8:11], s60 offen sc1 lds
f_ds11:
    v_mov_b32 v7, 2
    v_mov_b32 v4, 159804
    s_lshl_b32 s62, s56, 12
    s_lshl_b32 s3, s57, 7
    s_add_u32 s62, s62, s3
    s_add_u32 s62, s62, 196608
    s_lshl_b32 s59, s57, 2
    s_add_u32 s59, s59, s56
    s_lshl_b32 s60, s59, 11
    s_and_b32 s60, s60, 4294963200
    s_and_b32 s3, s56, 1
    s_mul_i32 s63, s3, 1179648
    s_lshl_b32 s3, s3, 6
    s_add_u32 s60, s60, s3
    s_add_u32 s60, s60, 3145728
    s_lshl_b32 s59, s59, 14
    s_add_u32 s59, s59, 1048576
    s_mul_i32 s3, s70, 1152
    s_add_u32 s63, s63, s3
    s_add_u32 s63, s63, s71
    s_waitcnt vmcnt(0)
    ds_write_b32 v116, v7
    s_branch f_t9
f_t9_z:
    s_sleep 4
f_t9:
    ds_read_b32 v9, v115
    s_waitcnt lgkmcnt(0)
    v_cmp_gt_i32 vcc, 2, v9
    s_cbranch_vccnz f_t9_z
    s_branch f_t12
f_t12_z:
    s_sleep 4
f_t12:
    ds_read_b32 v9, v4
    s_waitcnt lgkmcnt(0)
    v_cmp_gt_i32 vcc, 4, v9
    s_cbranch_vccnz f_t12_z
    ds_read_b64_tr_b16 v[124:125], v157 offset:36864
    ds_read_b64_tr_b16 v[126:127], v157 offset:37008
    ds_read_b64_tr_b16 v[128:129], v157 offset:36896
    ds_read_b64_tr_b16 v[130:131], v157 offset:37040
    ds_read_b64_tr_b16 v[132:133], v157 offset:36928
    ds_read_b64_tr_b16 v[134:135], v157 offset:37072
    ds_read_b64_tr_b16 v[136:137], v157 offset:36960
    ds_read_b64_tr_b16 v[138:139], v157 offset:37104
    ds_read_b64_tr_b16 v[140:141], v157 offset:36992
    ds_read_b64_tr_b16 v[142:143], v157 offset:37136
    ds_read_b64_tr_b16 v[144:145], v157 offset:41472
    ds_read_b64_tr_b16 v[146:147], v157 offset:41616
    ds_read_b64_tr_b16 v[148:149], v157 offset:41504
    ds_read_b64_tr_b16 v[150:151], v157 offset:41648
    s_waitcnt lgkmcnt(10)
    v_mfma_f32_16x16x32_bf16 v[16:19], v[124:127], v[36:39], 0
    ds_read_b64_tr_b16 v[152:153], v157 offset:41536
    ds_read_b64_tr_b16 v[154:155], v157 offset:41680
    v_mfma_f32_16x16x32_bf16 v[20:23], v[128:131], v[36:39], 0
    ds_read_b64_tr_b16 v[124:125], v157 offset:41568
    ds_read_b64_tr_b16 v[126:127], v157 offset:41712
    s_waitcnt lgkmcnt(10)
    v_mfma_f32_16x16x32_bf16 v[24:27], v[132:135], v[36:39], 0
    ds_read_b64_tr_b16 v[128:129], v157 offset:41600
    ds_read_b64_tr_b16 v[130:131], v157 offset:41744
    v_mfma_f32_16x16x32_bf16 v[28:31], v[136:139], v[36:39], 0
    ds_read_b64_tr_b16 v[132:133], v157 offset:46080
    ds_read_b64_tr_b16 v[134:135], v157 offset:46224
    s_waitcnt lgkmcnt(10)
    v_mfma_f32_16x16x32_bf16 v[32:35], v[140:143], v[36:39], 0
    ds_read_b64_tr_b16 v[136:137], v157 offset:46112
    ds_read_b64_tr_b16 v[138:139], v157 offset:46256
    v_mfma_f32_16x16x32_bf16 v[16:19], v[144:147], v[40:43], v[16:19]
    ds_read_b64_tr_b16 v[140:141], v157 offset:46144
    ds_read_b64_tr_b16 v[142:143], v157 offset:46288
    s_waitcnt lgkmcnt(10)
    v_mfma_f32_16x16x32_bf16 v[20:23], v[148:151], v[40:43], v[20:23]
    ds_read_b64_tr_b16 v[144:145], v157 offset:46176
    ds_read_b64_tr_b16 v[146:147], v157 offset:46320
    v_mfma_f32_16x16x32_bf16 v[24:27], v[152:155], v[40:43], v[24:27]
    ds_read_b64_tr_b16 v[148:149], v157 offset:46208
    ds_read_b64_tr_b16 v[150:151], v157 offset:46352
    s_waitcnt lgkmcnt(10)
    v_mfma_f32_16x16x32_bf16 v[28:31], v[124:127], v[40:43], v[28:31]
    ds_read_b64_tr_b16 v[152:153], v157 offset:50688
    ds_read_b64_tr_b16 v[154:155], v157 offset:50832
    v_mfma_f32_16x16x32_bf16 v[32:35], v[128:131], v[40:43], v[32:35]
    ds_read_b64_tr_b16 v[124:125], v157 offset:50720
    ds_read_b64_tr_b16 v[126:127], v157 offset:50864
    s_waitcnt lgkmcnt(10)
    v_mfma_f32_16x16x32_bf16 v[16:19], v[132:135], v[44:47], v[16:19]
    ds_read_b64_tr_b16 v[128:129], v157 offset:50752
    ds_read_b64_tr_b16 v[130:131], v157 offset:50896
    v_mfma_f32_16x16x32_bf16 v[20:23], v[136:139], v[44:47], v[20:23]
    ds_read_b64_tr_b16 v[132:133], v157 offset:50784
    ds_read_b64_tr_b16 v[134:135], v157 offset:50928
    s_waitcnt lgkmcnt(10)
    v_mfma_f32_16x16x32_bf16 v[24:27], v[140:143], v[44:47], v[24:27]
    ds_read_b64_tr_b16 v[136:137], v157 offset:50816
    ds_read_b64_tr_b16 v[138:139], v157 offset:50960
    v_mfma_f32_16x16x32_bf16 v[28:31], v[144:147], v[44:47], v[28:31]
    ds_read_b64_tr_b16 v[140:141], v158 offset:0
    ds_read_b64_tr_b16 v[142:143], v158 offset:144
    s_waitcnt lgkmcnt(10)
    v_mfma_f32_16x16x32_bf16 v[32:35], v[148:151], v[44:47], v[32:35]
    ds_read_b64_tr_b16 v[144:145], v158 offset:32
    ds_read_b64_tr_b16 v[146:147], v158 offset:176
    v_mfma_f32_16x16x32_bf16 v[16:19], v[152:155], v[48:51], v[16:19]
    ds_read_b64_tr_b16 v[148:149], v158 offset:64
    ds_read_b64_tr_b16 v[150:151], v158 offset:208
    s_waitcnt lgkmcnt(10)
    v_mfma_f32_16x16x32_bf16 v[20:23], v[124:127], v[48:51], v[20:23]
    ds_read_b64_tr_b16 v[152:153], v158 offset:96
    ds_read_b64_tr_b16 v[154:155], v158 offset:240
    v_mfma_f32_16x16x32_bf16 v[24:27], v[128:131], v[48:51], v[24:27]
    ds_read_b64_tr_b16 v[124:125], v158 offset:128
    ds_read_b64_tr_b16 v[126:127], v158 offset:272
    s_waitcnt lgkmcnt(10)
    v_mfma_f32_16x16x32_bf16 v[28:31], v[132:135], v[48:51], v[28:31]
    ds_read_b64_tr_b16 v[128:129], v158 offset:4608
    ds_read_b64_tr_b16 v[130:131], v158 offset:4752
    v_mfma_f32_16x16x32_bf16 v[32:35], v[136:139], v[48:51], v[32:35]
    ds_read_b64_tr_b16 v[132:133], v158 offset:4640
    ds_read_b64_tr_b16 v[134:135], v158 offset:4784
    s_nop 3
    v_mul_f32 v16, v16, v15
    v_mul_f32 v17, v17, v15
    v_mul_f32 v18, v18, v15
    v_mul_f32 v19, v19, v15
    v_mul_f32 v20, v20, v15
    v_mul_f32 v21, v21, v15
    v_mul_f32 v22, v22, v15
    v_mul_f32 v23, v23, v15
    v_mul_f32 v24, v24, v15
    v_mul_f32 v25, v25, v15
    v_mul_f32 v26, v26, v15
    v_mul_f32 v27, v27, v15
    v_mul_f32 v28, v28, v15
    v_mul_f32 v29, v29, v15
    v_mul_f32 v30, v30, v15
    v_mul_f32 v31, v31, v15
    v_mul_f32 v32, v32, v15
    v_mul_f32 v33, v33, v15
    v_mul_f32 v34, v34, v15
    v_mul_f32 v35, v35, v15
    s_mov_b32 s66, 0
    s_mov_b64 exec, 255
f_t10:
    v_mov_b32 v12, 0
    v_mov_b32 v13, 0
    buffer_atomic_or_x2 v[12:13], v160, s[8:11], s62 offen sc0 sc1
    s_add_u32 s66, s66, 1
    s_waitcnt vmcnt(0) lgkmcnt(0)
    v_cmp_ne_u64 vcc, s[54:55], v[12:13]
    s_cbranch_vccz f_t10_ok
    s_sleep 1
    s_cmp_lt_u32 s66, 20000
    s_cbranch_scc1 f_t10
f_t10_ok:
    s_mov_b64 exec, -1
    s_add_u32 s3, s58, 0
    s_and_b32 s3, s3, 7
    s_lshl_b32 s3, s3, 11
    s_add_u32 s3, s3, s59
    buffer_load_dwordx4 v[52:55], v156, s[8:11], s3 offen offset:0 sc1
    buffer_load_dwordx4 v[56:59], v156, s[8:11], s3 offen offset:1024 sc1
    s_add_u32 s3, s58, 1
    s_and_b32 s3, s3, 7
    s_lshl_b32 s3, s3, 11
    s_add_u32 s3, s3, s59
    buffer_load_dwordx4 v[60:63], v156, s[8:11], s3 offen offset:0 sc1
    buffer_load_dwordx4 v[64:67], v156, s[8:11], s3 offen offset:1024 sc1
    s_add_u32 s3, s58, 2
    s_and_b32 s3, s3, 7
    s_lshl_b32 s3, s3, 11
    s_add_u32 s3, s3, s59
    buffer_load_dwordx4 v[68:71], v156, s[8:11], s3 offen offset:0 sc1
    buffer_load_dwordx4 v[72:75], v156, s[8:11], s3 offen offset:1024 sc1
    s_add_u32 s3, s58, 3
    s_and_b32 s3, s3, 7
    s_lshl_b32 s3, s3, 11
    s_add_u32 s3, s3, s59
    buffer_load_dwordx4 v[76:79], v156, s[8:11], s3 offen offset:0 sc1
    buffer_load_dwordx4 v[80:83], v156, s[8:11], s3 offen offset:1024 sc1
    s_add_u32 s3, s58, 4
    s_and_b32 s3, s3, 7
    s_lshl_b32 s3, s3, 11
    s_add_u32 s3, s3, s59
    buffer_load_dwordx4 v[84:87], v156, s[8:11], s3 offen offset:0 sc1
    buffer_load_dwordx4 v[88:91], v156, s[8:11], s3 offen offset:1024 sc1
    s_add_u32 s3, s58, 5
    s_and_b32 s3, s3, 7
    s_lshl_b32 s3, s3, 11
    s_add_u32 s3, s3, s59
    buffer_load_dwordx4 v[92:95], v156, s[8:11], s3 offen offset:0 sc1
    buffer_load_dwordx4 v[96:99], v156, s[8:11], s3 offen offset:1024 sc1
    s_add_u32 s3, s58, 6
    s_and_b32 s3, s3, 7
    s_lshl_b32 s3, s3, 11
    s_add_u32 s3, s3, s59
    buffer_load_dwordx4 v[100:103], v156, s[8:11], s3 offen offset:0 sc1
    buffer_load_dwordx4 v[104:107], v156, s[8:11], s3 offen offset:1024 sc1
    s_add_u32 s3, s58, 7
    s_and_b32 s3, s3, 7
    s_lshl_b32 s3, s3, 11
    s_add_u32 s3, s3, s59
    buffer_load_dwordx4 v[108:111], v156, s[8:11], s3 offen offset:0 sc1
    buffer_load_dwordx4 v[112:115], v156, s[8:11], s3 offen offset:1024 sc1
    buffer_load_dword v116, v159, s[8:11], s60 offen offset:0 sc1
    buffer_load_dword v117, v159, s[8:11], s60 offen offset:128 sc1
    buffer_load_dword v118, v159, s[8:11], s60 offen offset:256 sc1
    buffer_load_dword v119, v159, s[8:11], s60 offen offset:384 sc1
    buffer_load_dword v120, v159, s[8:11], s60 offen offset:2048 sc1
    buffer_load_dword v121, v159, s[8:11], s60 offen offset:2176 sc1
    buffer_load_dword v122, v159, s[8:11], s60 offen offset:2304 sc1
    buffer_load_dword v123, v159, s[8:11], s60 offen offset:2432 sc1
    s_waitcnt vmcnt(23)
    s_waitcnt lgkmcnt(10)
    v_mfma_f32_16x16x32_bf16 v[16:19], v[140:143], v[52:55], v[16:19]
    ds_read_b64_tr_b16 v[136:137], v158 offset:4672
    ds_read_b64_tr_b16 v[138:139], v158 offset:4816
    v_mfma_f32_16x16x32_bf16 v[20:23], v[144:147], v[52:55], v[20:23]
    ds_read_b64_tr_b16 v[140:141], v158 offset:4704
    ds_read_b64_tr_b16 v[142:143], v158 offset:4848
    s_waitcnt lgkmcnt(10)
    v_mfma_f32_16x16x32_bf16 v[24:27], v[148:151], v[52:55], v[24:27]
    ds_read_b64_tr_b16 v[144:145], v158 offset:4736
    ds_read_b64_tr_b16 v[146:147], v158 offset:4880
    v_mfma_f32_16x16x32_bf16 v[28:31], v[152:155], v[52:55], v[28:31]
    ds_read_b64_tr_b16 v[148:149], v158 offset:9216
    ds_read_b64_tr_b16 v[150:151], v158 offset:9360
    s_waitcnt lgkmcnt(10)
    v_mfma_f32_16x16x32_bf16 v[32:35], v[124:127], v[52:55], v[32:35]
    ds_read_b64_tr_b16 v[152:153], v158 offset:9248
    ds_read_b64_tr_b16 v[154:155], v158 offset:9392
    s_waitcnt vmcnt(22)
    v_mfma_f32_16x16x32_bf16 v[16:19], v[128:131], v[56:59], v[16:19]
    ds_read_b64_tr_b16 v[124:125], v158 offset:9280
    ds_read_b64_tr_b16 v[126:127], v158 offset:9424
    s_waitcnt lgkmcnt(10)
    v_mfma_f32_16x16x32_bf16 v[20:23], v[132:135], v[56:59], v[20:23]
    ds_read_b64_tr_b16 v[128:129], v158 offset:9312
    ds_read_b64_tr_b16 v[130:131], v158 offset:9456
    v_mfma_f32_16x16x32_bf16 v[24:27], v[136:139], v[56:59], v[24:27]
    ds_read_b64_tr_b16 v[132:133], v158 offset:9344
    ds_read_b64_tr_b16 v[134:135], v158 offset:9488
    s_waitcnt lgkmcnt(10)
    v_mfma_f32_16x16x32_bf16 v[28:31], v[140:143], v[56:59], v[28:31]
    ds_read_b64_tr_b16 v[136:137], v158 offset:13824
    ds_read_b64_tr_b16 v[138:139], v158 offset:13968
    v_mfma_f32_16x16x32_bf16 v[32:35], v[144:147], v[56:59], v[32:35]
    ds_read_b64_tr_b16 v[140:141], v158 offset:13856
    ds_read_b64_tr_b16 v[142:143], v158 offset:14000
    s_waitcnt vmcnt(21)
    s_waitcnt lgkmcnt(10)
    v_mfma_f32_16x16x32_bf16 v[16:19], v[148:151], v[60:63], v[16:19]
    ds_read_b64_tr_b16 v[144:145], v158 offset:13888
    ds_read_b64_tr_b16 v[146:147], v158 offset:14032
    v_mfma_f32_16x16x32_bf16 v[20:23], v[152:155], v[60:63], v[20:23]
    ds_read_b64_tr_b16 v[148:149], v158 offset:13920
    ds_read_b64_tr_b16 v[150:151], v158 offset:14064
    s_waitcnt lgkmcnt(10)
    v_mfma_f32_16x16x32_bf16 v[24:27], v[124:127], v[60:63], v[24:27]
    ds_read_b64_tr_b16 v[152:153], v158 offset:13952
    ds_read_b64_tr_b16 v[154:155], v158 offset:14096
    v_mfma_f32_16x16x32_bf16 v[28:31], v[128:131], v[60:63], v[28:31]
    ds_read_b64_tr_b16 v[124:125], v158 offset:18432
    ds_read_b64_tr_b16 v[126:127], v158 offset:18576
    s_waitcnt lgkmcnt(10)
    v_mfma_f32_16x16x32_bf16 v[32:35], v[132:135], v[60:63], v[32:35]
    ds_read_b64_tr_b16 v[128:129], v158 offset:18464
    ds_read_b64_tr_b16 v[130:131], v158 offset:18608
    s_waitcnt vmcnt(20)
    v_mfma_f32_16x16x32_bf16 v[16:19], v[136:139], v[64:67], v[16:19]
    ds_read_b64_tr_b16 v[132:133], v158 offset:18496
    ds_read_b64_tr_b16 v[134:135], v158 offset:18640
    s_waitcnt lgkmcnt(10)
    v_mfma_f32_16x16x32_bf16 v[20:23], v[140:143], v[64:67], v[20:23]
    ds_read_b64_tr_b16 v[136:137], v158 offset:18528
    ds_read_b64_tr_b16 v[138:139], v158 offset:18672
    v_mfma_f32_16x16x32_bf16 v[24:27], v[144:147], v[64:67], v[24:27]
    ds_read_b64_tr_b16 v[140:141], v158 offset:18560
    ds_read_b64_tr_b16 v[142:143], v158 offset:18704
    s_waitcnt lgkmcnt(10)
    v_mfma_f32_16x16x32_bf16 v[28:31], v[148:151], v[64:67], v[28:31]
    ds_read_b64_tr_b16 v[144:145], v158 offset:23040
    ds_read_b64_tr_b16 v[146:147], v158 offset:23184
    v_mfma_f32_16x16x32_bf16 v[32:35], v[152:155], v[64:67], v[32:35]
    ds_read_b64_tr_b16 v[148:149], v158 offset:23072
    ds_read_b64_tr_b16 v[150:151], v158 offset:23216
    s_waitcnt vmcnt(19)
    s_waitcnt lgkmcnt(10)
    v_mfma_f32_16x16x32_bf16 v[16:19], v[124:127], v[68:71], v[16:19]
    ds_read_b64_tr_b16 v[152:153], v158 offset:23104
    ds_read_b64_tr_b16 v[154:155], v158 offset:23248
    v_mfma_f32_16x16x32_bf16 v[20:23], v[128:131], v[68:71], v[20:23]
    ds_read_b64_tr_b16 v[124:125], v158 offset:23136
    ds_read_b64_tr_b16 v[126:127], v158 offset:23280
    s_waitcnt lgkmcnt(10)
    v_mfma_f32_16x16x32_bf16 v[24:27], v[132:135], v[68:71], v[24:27]
    ds_read_b64_tr_b16 v[128:129], v158 offset:23168
    ds_read_b64_tr_b16 v[130:131], v158 offset:23312
    v_mfma_f32_16x16x32_bf16 v[28:31], v[136:139], v[68:71], v[28:31]
    ds_read_b64_tr_b16 v[132:133], v158 offset:27648
    ds_read_b64_tr_b16 v[134:135], v158 offset:27792
    s_waitcnt lgkmcnt(10)
    v_mfma_f32_16x16x32_bf16 v[32:35], v[140:143], v[68:71], v[32:35]
    ds_read_b64_tr_b16 v[136:137], v158 offset:27680
    ds_read_b64_tr_b16 v[138:139], v158 offset:27824
    s_waitcnt vmcnt(18)
    v_mfma_f32_16x16x32_bf16 v[16:19], v[144:147], v[72:75], v[16:19]
    ds_read_b64_tr_b16 v[140:141], v158 offset:27712
    ds_read_b64_tr_b16 v[142:143], v158 offset:27856
    s_waitcnt lgkmcnt(10)
    v_mfma_f32_16x16x32_bf16 v[20:23], v[148:151], v[72:75], v[20:23]
    ds_read_b64_tr_b16 v[144:145], v158 offset:27744
    ds_read_b64_tr_b16 v[146:147], v158 offset:27888
    v_mfma_f32_16x16x32_bf16 v[24:27], v[152:155], v[72:75], v[24:27]
    ds_read_b64_tr_b16 v[148:149], v158 offset:27776
    ds_read_b64_tr_b16 v[150:151], v158 offset:27920
    s_waitcnt lgkmcnt(10)
    v_mfma_f32_16x16x32_bf16 v[28:31], v[124:127], v[72:75], v[28:31]
    ds_read_b64_tr_b16 v[152:153], v158 offset:32256
    ds_read_b64_tr_b16 v[154:155], v158 offset:32400
    v_mfma_f32_16x16x32_bf16 v[32:35], v[128:131], v[72:75], v[32:35]
    ds_read_b64_tr_b16 v[124:125], v158 offset:32288
    ds_read_b64_tr_b16 v[126:127], v158 offset:32432
    s_waitcnt vmcnt(17)
    s_waitcnt lgkmcnt(10)
    v_mfma_f32_16x16x32_bf16 v[16:19], v[132:135], v[76:79], v[16:19]
    ds_read_b64_tr_b16 v[128:129], v158 offset:32320
    ds_read_b64_tr_b16 v[130:131], v158 offset:32464
    v_mfma_f32_16x16x32_bf16 v[20:23], v[136:139], v[76:79], v[20:23]
    ds_read_b64_tr_b16 v[132:133], v158 offset:32352
    ds_read_b64_tr_b16 v[134:135], v158 offset:32496
    s_waitcnt lgkmcnt(10)
    v_mfma_f32_16x16x32_bf16 v[24:27], v[140:143], v[76:79], v[24:27]
    ds_read_b64_tr_b16 v[136:137], v158 offset:32384
    ds_read_b64_tr_b16 v[138:139], v158 offset:32528
    v_mfma_f32_16x16x32_bf16 v[28:31], v[144:147], v[76:79], v[28:31]
    ds_read_b64_tr_b16 v[140:141], v158 offset:36864
    ds_read_b64_tr_b16 v[142:143], v158 offset:37008
    s_waitcnt lgkmcnt(10)
    v_mfma_f32_16x16x32_bf16 v[32:35], v[148:151], v[76:79], v[32:35]
    ds_read_b64_tr_b16 v[144:145], v158 offset:36896
    ds_read_b64_tr_b16 v[146:147], v158 offset:37040
    s_waitcnt vmcnt(16)
    v_mfma_f32_16x16x32_bf16 v[16:19], v[152:155], v[80:83], v[16:19]
    ds_read_b64_tr_b16 v[148:149], v158 offset:36928
    ds_read_b64_tr_b16 v[150:151], v158 offset:37072
    s_waitcnt lgkmcnt(10)
    v_mfma_f32_16x16x32_bf16 v[20:23], v[124:127], v[80:83], v[20:23]
    ds_read_b64_tr_b16 v[152:153], v158 offset:36960
    ds_read_b64_tr_b16 v[154:155], v158 offset:37104
    v_mfma_f32_16x16x32_bf16 v[24:27], v[128:131], v[80:83], v[24:27]
    ds_read_b64_tr_b16 v[124:125], v158 offset:36992
    ds_read_b64_tr_b16 v[126:127], v158 offset:37136
    s_waitcnt lgkmcnt(10)
    v_mfma_f32_16x16x32_bf16 v[28:31], v[132:135], v[80:83], v[28:31]
    ds_read_b64_tr_b16 v[128:129], v158 offset:41472
    ds_read_b64_tr_b16 v[130:131], v158 offset:41616
    v_mfma_f32_16x16x32_bf16 v[32:35], v[136:139], v[80:83], v[32:35]
    ds_read_b64_tr_b16 v[132:133], v158 offset:41504
    ds_read_b64_tr_b16 v[134:135], v158 offset:41648
    s_waitcnt vmcnt(15)
    s_waitcnt lgkmcnt(10)
    v_mfma_f32_16x16x32_bf16 v[16:19], v[140:143], v[84:87], v[16:19]
    ds_read_b64_tr_b16 v[136:137], v158 offset:41536
    ds_read_b64_tr_b16 v[138:139], v158 offset:41680
    v_mfma_f32_16x16x32_bf16 v[20:23], v[144:147], v[84:87], v[20:23]
    ds_read_b64_tr_b16 v[140:141], v158 offset:41568
    ds_read_b64_tr_b16 v[142:143], v158 offset:41712
    s_waitcnt lgkmcnt(10)
    v_mfma_f32_16x16x32_bf16 v[24:27], v[148:151], v[84:87], v[24:27]
    ds_read_b64_tr_b16 v[144:145], v158 offset:41600
    ds_read_b64_tr_b16 v[146:147], v158 offset:41744
    v_mfma_f32_16x16x32_bf16 v[28:31], v[152:155], v[84:87], v[28:31]
    ds_read_b64_tr_b16 v[148:149], v157 offset:0
    ds_read_b64_tr_b16 v[150:151], v157 offset:144
    s_waitcnt lgkmcnt(10)
    v_mfma_f32_16x16x32_bf16 v[32:35], v[124:127], v[84:87], v[32:35]
    ds_read_b64_tr_b16 v[152:153], v157 offset:32
    ds_read_b64_tr_b16 v[154:155], v157 offset:176
    s_waitcnt vmcnt(14)
    v_mfma_f32_16x16x32_bf16 v[16:19], v[128:131], v[88:91], v[16:19]
    ds_read_b64_tr_b16 v[124:125], v157 offset:64
    ds_read_b64_tr_b16 v[126:127], v157 offset:208
    s_waitcnt lgkmcnt(10)
    v_mfma_f32_16x16x32_bf16 v[20:23], v[132:135], v[88:91], v[20:23]
    ds_read_b64_tr_b16 v[128:129], v157 offset:96
    ds_read_b64_tr_b16 v[130:131], v157 offset:240
    v_mfma_f32_16x16x32_bf16 v[24:27], v[136:139], v[88:91], v[24:27]
    ds_read_b64_tr_b16 v[132:133], v157 offset:128
    ds_read_b64_tr_b16 v[134:135], v157 offset:272
    s_waitcnt lgkmcnt(10)
    v_mfma_f32_16x16x32_bf16 v[28:31], v[140:143], v[88:91], v[28:31]
    ds_read_b64_tr_b16 v[136:137], v157 offset:4608
    ds_read_b64_tr_b16 v[138:139], v157 offset:4752
    v_mfma_f32_16x16x32_bf16 v[32:35], v[144:147], v[88:91], v[32:35]
    ds_read_b64_tr_b16 v[140:141], v157 offset:4640
    ds_read_b64_tr_b16 v[142:143], v157 offset:4784
    s_waitcnt vmcnt(13)
    s_waitcnt lgkmcnt(10)
    v_mfma_f32_16x16x32_bf16 v[16:19], v[148:151], v[92:95], v[16:19]
    ds_read_b64_tr_b16 v[144:145], v157 offset:4672
    ds_read_b64_tr_b16 v[146:147], v157 offset:4816
    v_mfma_f32_16x16x32_bf16 v[20:23], v[152:155], v[92:95], v[20:23]
    ds_read_b64_tr_b16 v[148:149], v157 offset:4704
    ds_read_b64_tr_b16 v[150:151], v157 offset:4848
    s_waitcnt lgkmcnt(10)
    v_mfma_f32_16x16x32_bf16 v[24:27], v[124:127], v[92:95], v[24:27]
    ds_read_b64_tr_b16 v[152:153], v157 offset:4736
    ds_read_b64_tr_b16 v[154:155], v157 offset:4880
    v_mfma_f32_16x16x32_bf16 v[28:31], v[128:131], v[92:95], v[28:31]
    ds_read_b64_tr_b16 v[124:125], v157 offset:9216
    ds_read_b64_tr_b16 v[126:127], v157 offset:9360
    s_waitcnt lgkmcnt(10)
    v_mfma_f32_16x16x32_bf16 v[32:35], v[132:135], v[92:95], v[32:35]
    ds_read_b64_tr_b16 v[128:129], v157 offset:9248
    ds_read_b64_tr_b16 v[130:131], v157 offset:9392
    s_waitcnt vmcnt(12)
    v_mfma_f32_16x16x32_bf16 v[16:19], v[136:139], v[96:99], v[16:19]
    ds_read_b64_tr_b16 v[132:133], v157 offset:9280
    ds_read_b64_tr_b16 v[134:135], v157 offset:9424
    s_waitcnt lgkmcnt(10)
    v_mfma_f32_16x16x32_bf16 v[20:23], v[140:143], v[96:99], v[20:23]
    ds_read_b64_tr_b16 v[136:137], v157 offset:9312
    ds_read_b64_tr_b16 v[138:139], v157 offset:9456
    v_mfma_f32_16x16x32_bf16 v[24:27], v[144:147], v[96:99], v[24:27]
    ds_read_b64_tr_b16 v[140:141], v157 offset:9344
    ds_read_b64_tr_b16 v[142:143], v157 offset:9488
    s_waitcnt lgkmcnt(10)
    v_mfma_f32_16x16x32_bf16 v[28:31], v[148:151], v[96:99], v[28:31]
    ds_read_b64_tr_b16 v[144:145], v157 offset:13824
    ds_read_b64_tr_b16 v[146:147], v157 offset:13968
    v_mfma_f32_16x16x32_bf16 v[32:35], v[152:155], v[96:99], v[32:35]
    ds_read_b64_tr_b16 v[148:149], v157 offset:13856
    ds_read_b64_tr_b16 v[150:151], v157 offset:14000
    s_waitcnt vmcnt(11)
    s_waitcnt lgkmcnt(10)
    v_mfma_f32_16x16x32_bf16 v[16:19], v[124:127], v[100:103], v[16:19]
    ds_read_b64_tr_b16 v[152:153], v157 offset:13888
    ds_read_b64_tr_b16 v[154:155], v157 offset:14032
    v_mfma_f32_16x16x32_bf16 v[20:23], v[128:131], v[100:103], v[20:23]
    ds_read_b64_tr_b16 v[124:125], v157 offset:13920
    ds_read_b64_tr_b16 v[126:127], v157 offset:14064
    s_waitcnt lgkmcnt(10)
    v_mfma_f32_16x16x32_bf16 v[24:27], v[132:135], v[100:103], v[24:27]
    ds_read_b64_tr_b16 v[128:129], v157 offset:13952
    ds_read_b64_tr_b16 v[130:131], v157 offset:14096
    v_mfma_f32_16x16x32_bf16 v[28:31], v[136:139], v[100:103], v[28:31]
    ds_read_b64_tr_b16 v[132:133], v157 offset:18432
    ds_read_b64_tr_b16 v[134:135], v157 offset:18576
    s_waitcnt lgkmcnt(10)
    v_mfma_f32_16x16x32_bf16 v[32:35], v[140:143], v[100:103], v[32:35]
    ds_read_b64_tr_b16 v[136:137], v157 offset:18464
    ds_read_b64_tr_b16 v[138:139], v157 offset:18608
    s_waitcnt vmcnt(10)
    v_mfma_f32_16x16x32_bf16 v[16:19], v[144:147], v[104:107], v[16:19]
    ds_read_b64_tr_b16 v[140:141], v157 offset:18496
    ds_read_b64_tr_b16 v[142:143], v157 offset:18640
    s_waitcnt lgkmcnt(10)
    v_mfma_f32_16x16x32_bf16 v[20:23], v[148:151], v[104:107], v[20:23]
    ds_read_b64_tr_b16 v[144:145], v157 offset:18528
    ds_read_b64_tr_b16 v[146:147], v157 offset:18672
    v_mfma_f32_16x16x32_bf16 v[24:27], v[152:155], v[104:107], v[24:27]
    ds_read_b64_tr_b16 v[148:149], v157 offset:18560
    ds_read_b64_tr_b16 v[150:151], v157 offset:18704
    s_waitcnt lgkmcnt(10)
    v_mfma_f32_16x16x32_bf16 v[28:31], v[124:127], v[104:107], v[28:31]
    ds_read_b64_tr_b16 v[152:153], v157 offset:23040
    ds_read_b64_tr_b16 v[154:155], v157 offset:23184
    v_mfma_f32_16x16x32_bf16 v[32:35], v[128:131], v[104:107], v[32:35]
    ds_read_b64_tr_b16 v[124:125], v157 offset:23072
    ds_read_b64_tr_b16 v[126:127], v157 offset:23216
    s_waitcnt vmcnt(9)
    s_waitcnt lgkmcnt(10)
    v_mfma_f32_16x16x32_bf16 v[16:19], v[132:135], v[108:111], v[16:19]
    ds_read_b64_tr_b16 v[128:129], v157 offset:23104
    ds_read_b64_tr_b16 v[130:131], v157 offset:23248
    v_mfma_f32_16x16x32_bf16 v[20:23], v[136:139], v[108:111], v[20:23]
    ds_read_b64_tr_b16 v[132:133], v157 offset:23136
    ds_read_b64_tr_b16 v[134:135], v157 offset:23280
    s_waitcnt lgkmcnt(10)
    v_mfma_f32_16x16x32_bf16 v[24:27], v[140:143], v[108:111], v[24:27]
    ds_read_b64_tr_b16 v[136:137], v157 offset:23168
    ds_read_b64_tr_b16 v[138:139], v157 offset:23312
    v_mfma_f32_16x16x32_bf16 v[28:31], v[144:147], v[108:111], v[28:31]
    ds_read_b64_tr_b16 v[140:141], v157 offset:27648
    ds_read_b64_tr_b16 v[142:143], v157 offset:27792
    s_waitcnt lgkmcnt(10)
    v_mfma_f32_16x16x32_bf16 v[32:35], v[148:151], v[108:111], v[32:35]
    ds_read_b64_tr_b16 v[144:145], v157 offset:27680
    ds_read_b64_tr_b16 v[146:147], v157 offset:27824
    s_waitcnt vmcnt(8)
    v_mfma_f32_16x16x32_bf16 v[16:19], v[152:155], v[112:115], v[16:19]
    ds_read_b64_tr_b16 v[148:149], v157 offset:27712
    ds_read_b64_tr_b16 v[150:151], v157 offset:27856
    s_waitcnt lgkmcnt(10)
    v_mfma_f32_16x16x32_bf16 v[20:23], v[124:127], v[112:115], v[20:23]
    ds_read_b64_tr_b16 v[152:153], v157 offset:27744
    ds_read_b64_tr_b16 v[154:155], v157 offset:27888
    v_mfma_f32_16x16x32_bf16 v[24:27], v[128:131], v[112:115], v[24:27]
    ds_read_b64_tr_b16 v[124:125], v157 offset:27776
    ds_read_b64_tr_b16 v[126:127], v157 offset:27920
    s_waitcnt lgkmcnt(10)
    v_mfma_f32_16x16x32_bf16 v[28:31], v[132:135], v[112:115], v[28:31]
    ds_read_b64_tr_b16 v[128:129], v157 offset:32256
    ds_read_b64_tr_b16 v[130:131], v157 offset:32400
    v_mfma_f32_16x16x32_bf16 v[32:35], v[136:139], v[112:115], v[32:35]
    ds_read_b64_tr_b16 v[132:133], v157 offset:32288
    ds_read_b64_tr_b16 v[134:135], v157 offset:32432
    s_waitcnt vmcnt(4)
    s_waitcnt lgkmcnt(10)
    v_mfma_f32_16x16x32_bf16 v[16:19], v[140:143], v[116:119], v[16:19]
    ds_read_b64_tr_b16 v[136:137], v157 offset:32320
    ds_read_b64_tr_b16 v[138:139], v157 offset:32464
    v_mfma_f32_16x16x32_bf16 v[20:23], v[144:147], v[116:119], v[20:23]
    ds_read_b64_tr_b16 v[140:141], v157 offset:32352
    ds_read_b64_tr_b16 v[142:143], v157 offset:32496
    s_waitcnt lgkmcnt(10)
    v_mfma_f32_16x16x32_bf16 v[24:27], v[148:151], v[116:119], v[24:27]
    ds_read_b64_tr_b16 v[144:145], v157 offset:32384
    ds_read_b64_tr_b16 v[146:147], v157 offset:32528
    v_mfma_f32_16x16x32_bf16 v[28:31], v[152:155], v[116:119], v[28:31]
    s_waitcnt lgkmcnt(8)
    v_mfma_f32_16x16x32_bf16 v[32:35], v[124:127], v[116:119], v[32:35]
    s_waitcnt vmcnt(0)
    v_mfma_f32_16x16x32_bf16 v[16:19], v[128:131], v[120:123], v[16:19]
    s_waitcnt lgkmcnt(4)
    v_mfma_f32_16x16x32_bf16 v[20:23], v[132:135], v[120:123], v[20:23]
    v_mfma_f32_16x16x32_bf16 v[24:27], v[136:139], v[120:123], v[24:27]
    s_waitcnt lgkmcnt(0)
    v_mfma_f32_16x16x32_bf16 v[28:31], v[140:143], v[120:123], v[28:31]
    v_mfma_f32_16x16x32_bf16 v[32:35], v[144:147], v[120:123], v[32:35]
    s_nop 3
    v_cvt_pk_bf16_f32 v36, v16, v17
    v_cvt_pk_bf16_f32 v37, v18, v19
    ds_write_b64 v164, v[36:37] offset:0
    v_cvt_pk_bf16_f32 v38, v20, v21
    v_cvt_pk_bf16_f32 v39, v22, v23
    ds_write_b64 v164, v[38:39] offset:32
    v_cvt_pk_bf16_f32 v40, v24, v25
    v_cvt_pk_bf16_f32 v41, v26, v27
    ds_write_b64 v164, v[40:41] offset:64
    v_cvt_pk_bf16_f32 v42, v28, v29
    v_cvt_pk_bf16_f32 v43, v30, v31
    ds_write_b64 v164, v[42:43] offset:96
    s_mov_b32 exec_hi, 0
    v_cvt_pk_bf16_f32 v44, v32, v33
    v_cvt_pk_bf16_f32 v45, v34, v35
    ds_write_b64 v164, v[44:45] offset:128
    s_mov_b32 exec_hi, -1
    ds_read_b128 v[52:55], v165 offset:0
    ds_read_b128 v[56:59], v165 offset:1024
    ds_read_b128 v[60:63], v165 offset:2048
    s_waitcnt lgkmcnt(2)
    buffer_store_dwordx4 v[52:55], v161, s[48:51], s63 offen
    s_waitcnt lgkmcnt(1)
    buffer_store_dwordx4 v[56:59], v162, s[48:51], s63 offen
    s_waitcnt lgkmcnt(0)
    s_mov_b64 exec, 0xffff
    buffer_store_dwordx4 v[60:63], v163, s[48:51], s63 offen
    s_endpgm
f_att:
    s_barrier
    s_sub_u32 s70, s56, 4
    s_getpc_b64 s[4:5]
f_pf:
    s_sub_u32 s4, s4, f_pf-f_code
    s_subb_u32 s5, s5, 0
    s_lshr_b32 s3, s2, 3
    s_lshl_b32 s6, s70, 6
    s_add_u32 s3, s3, s6
    v_lshlrev_b32 v2, 5, v1
    v_add_u32 v2, s3, v2
    v_lshlrev_b32 v2, 7, v2
    v_min_u32 v2, rf_end-f_code-4, v2
    s_mov_b64 exec, 3
    global_load_dword v130, v2, s[4:5]
    s_mov_b64 exec, -1
    v_lshrrev_b32 v2, 5, v1
    v_lshrrev_b32 v3, 2, v1
    v_xor_b32 v2, v2, v3
    v_and_b32 v2, 3, v2
    v_and_b32 v3, 31, v1
    v_lshlrev_b32 v3, 6, v3
    v_lshl_add_u32 v111, v2, 4, v3
    s_lshr_b32 s71, s70, 2
    s_and_b32 s72, s70, 3
    s_and_b32 s3, s58, 1
    s_mul_i32 s3, s3, 36864
    v_add_u32 v110, s3, v111
    v_and_b32 v108, 3, v1
    v_min_u32 v108, 2, v108
    v_lshlrev_b32 v108, 2, v108
    v_add_u32 v108, 159840, v108
    s_lshl_b32 s3, s70, 2
    s_add_u32 s3, s3, 159760
    v_mov_b32 v109, s3
    v_and_b32 v14, 31, v1
    v_lshrrev_b32 v15, 5, v1
    v_lshlrev_b32 v129, 2, v14
    v_lshlrev_b32 v115, 4, v1
    s_mul_i32 s6, s71, 2432
    s_add_u32 s6, s6, 110592
    v_add_u32 v11, s6, v115
    s_add_u32 s3, s6, 1024
    v_add_u32 v12, s3, v129
    v_cmp_gt_u32 vcc, 19, v14
    v_mul_u32_u24 v2, 19, v15
    v_add_u32 v13, v14, v2
    v_cndmask_b32 v13, 38, v13, vcc
    v_cmp_eq_u32 vcc, 22, v14
    s_add_u32 s3, s6, 1152
    v_mad_u32_u24 v3, v15, 15, 4
    v_lshlrev_b32 v13, 4, v13
    v_add_u32 v13, s3, v13
    s_lshl_b32 s3, s72, 1
    s_add_u32 s3, s3, s71
    s_mul_i32 s3, s3, 1536
    s_add_u32 s3, s3, 143360
    v_add_u32 v131, s3, v115
    s_lshl_b32 s73, s58, 2
    s_add_u32 s73, s73, s72
    s_lshl_b32 s60, s57, 13
    s_lshl_b32 s3, s73, 7
    s_add_u32 s60, s60, s3
    s_add_u32 s77, s60, 3145728
    s_lshl_b32 s59, s57, 16
    s_lshl_b32 s3, s73, 9
    s_add_u32 s59, s59, s3
    s_add_u32 s76, s59, 1048576
    s_add_u32 s78, s76, 32768
    s_add_u32 s79, s77, 4096
    v_lshrrev_b32 v15, 5, v1
    v_and_b32 v128, 15, v1
    v_lshlrev_b32 v128, 4, v128
    v_bfe_u32 v3, v1, 4, 1
    v_lshl_add_u32 v128, v3, 14, v128
    v_lshl_add_u32 v128, v15, 8, v128
    s_waitcnt lgkmcnt(0)
    s_load_dwordx2 s[54:55], s[52:53], 0
    s_mov_b32 s8, s52
    s_mov_b32 s9, s53
    s_mov_b32 s10, 19922944
    s_mov_b32 s11, 0x20000
    s_mul_i32 s3, s71, 36864
    v_add_u32 v111, s3, v111
    v_xor_b32 v112, 32, v111
    s_bitcmp1_b32 s72, 0
    s_mov_b32 s60, 0x34343120
    s_mov_b32 s61, 110592
    s_cmov_b32 s60, 0x44423120
    s_cmov_b32 s61, 110588
    s_mul_i32 s3, s72, 36
    s_add_u32 s61, s61, s3
    v_bfe_u32 v2, v1, 4, 1
    v_and_b32 v3, 3, v1
    v_lshl_add_u32 v2, v2, 2, v3
    v_lshlrev_b32 v2, 2, v2
    v_lshrrev_b32 v2, v2, s60
    v_and_b32 v2, 15, v2
    v_bfe_u32 v3, v1, 2, 2
    v_lshl_add_u32 v3, v3, 1, v15
    v_mul_u32_u24 v3, 288, v3
    v_lshl_add_u32 v113, v2, 3, v3
    v_add_u32 v113, s61, v113
    v_subrev_u32 v114, 36864, v113
    s_cmp_lg_u32 s71, 0
    s_cbranch_scc1 f_b0
    s_lshr_b32 s3, s58, 1
    s_lshl_b32 s3, s3, 2
    s_add_u32 s3, s3, s72
    s_cmp_lg_u32 s3, 2
    s_cbranch_scc1 f_a0
    v_xor_b32 v4, 32, v110
    v_lshlrev_b32 v5, 4, v15
    v_add_u32 v5, 156672, v5
    v_add_u32 v6, 160384, v129
    s_branch f_g1
f_g1_z:
    s_sleep 1
f_g1:
    ds_read_b32 v2, v108
    s_waitcnt lgkmcnt(0)
    v_cmp_gt_i32 vcc, 6, v2
    s_cbranch_vccnz f_g1_z
    ds_read_b128 v[32:35], v110 offset:0
    ds_read_b128 v[36:39], v5 offset:0
    ds_read_b128 v[40:43], v4 offset:0
    ds_read_b128 v[44:47], v5 offset:32
    ds_read_b128 v[48:51], v110 offset:2048
    ds_read_b128 v[52:55], v5 offset:64
    ds_read_b128 v[56:59], v4 offset:2048
    ds_read_b128 v[60:63], v5 offset:96
    s_waitcnt lgkmcnt(6)
    v_mfma_f32_32x32x16_bf16 v[16:31], v[36:39], v[32:35], 0
    s_waitcnt lgkmcnt(4)
    ds_read_b128 v[64:67], v110 offset:4096
    ds_read_b128 v[68:71], v5 offset:128
    ds_read_b128 v[72:75], v4 offset:4096
    ds_read_b128 v[76:79], v5 offset:160
    v_mfma_f32_32x32x16_bf16 v[16:31], v[44:47], v[40:43], v[16:31]
    s_waitcnt lgkmcnt(6)
    v_mfma_f32_32x32x16_bf16 v[16:31], v[52:55], v[48:51], v[16:31]
    s_waitcnt lgkmcnt(4)
    ds_read_b128 v[32:35], v110 offset:6144
    ds_read_b128 v[36:39], v5 offset:192
    ds_read_b128 v[40:43], v4 offset:6144
    ds_read_b128 v[44:47], v5 offset:224
    v_mfma_f32_32x32x16_bf16 v[16:31], v[60:63], v[56:59], v[16:31]
    s_waitcnt lgkmcnt(6)
    v_mfma_f32_32x32x16_bf16 v[16:31], v[68:71], v[64:67], v[16:31]
    s_waitcnt lgkmcnt(4)
    ds_read_b128 v[48:51], v110 offset:8192
    ds_read_b128 v[52:55], v5 offset:256
    ds_read_b128 v[56:59], v4 offset:8192
    ds_read_b128 v[60:63], v5 offset:288
    v_mfma_f32_32x32x16_bf16 v[16:31], v[76:79], v[72:75], v[16:31]
    s_waitcnt lgkmcnt(6)
    v_mfma_f32_32x32x16_bf16 v[16:31], v[36:39], v[32:35], v[16:31]
    s_waitcnt lgkmcnt(4)
    ds_read_b128 v[64:67], v110 offset:10240
    ds_read_b128 v[68:71], v5 offset:320
    ds_read_b128 v[72:75], v4 offset:10240
    ds_read_b128 v[76:79], v5 offset:352
    v_mfma_f32_32x32x16_bf16 v[16:31], v[44:47], v[40:43], v[16:31]
    s_waitcnt lgkmcnt(6)
    v_mfma_f32_32x32x16_bf16 v[16:31], v[52:55], v[48:51], v[16:31]
    s_waitcnt lgkmcnt(4)
    ds_read_b128 v[32:35], v110 offset:12288
    ds_read_b128 v[36:39], v5 offset:384
    ds_read_b128 v[40:43], v4 offset:12288
    ds_read_b128 v[44:47], v5 offset:416
    v_mfma_f32_32x32x16_bf16 v[16:31], v[60:63], v[56:59], v[16:31]
    s_waitcnt lgkmcnt(6)
    v_mfma_f32_32x32x16_bf16 v[16:31], v[68:71], v[64:67], v[16:31]
    s_waitcnt lgkmcnt(4)
    ds_read_b128 v[48:51], v110 offset:14336
    ds_read_b128 v[52:55], v5 offset:448
    ds_read_b128 v[56:59], v4 offset:14336
    ds_read_b128 v[60:63], v5 offset:480
    v_mfma_f32_32x32x16_bf16 v[16:31], v[76:79], v[72:75], v[16:31]
    s_waitcnt lgkmcnt(6)
    v_mfma_f32_32x32x16_bf16 v[16:31], v[36:39], v[32:35], v[16:31]
    s_waitcnt lgkmcnt(4)
    ds_read_b128 v[64:67], v110 offset:16384
    ds_read_b128 v[68:71], v5 offset:512
    ds_read_b128 v[72:75], v4 offset:16384
    ds_read_b128 v[76:79], v5 offset:544
    v_mfma_f32_32x32x16_bf16 v[16:31], v[44:47], v[40:43], v[16:31]
    s_waitcnt lgkmcnt(6)
    v_mfma_f32_32x32x16_bf16 v[16:31], v[52:55], v[48:51], v[16:31]
    s_waitcnt lgkmcnt(4)
    ds_read_b128 v[32:35], v110 offset:18432
    ds_read_b128 v[36:39], v5 offset:576
    ds_read_b128 v[40:43], v4 offset:18432
    ds_read_b128 v[44:47], v5 offset:608
    v_mfma_f32_32x32x16_bf16 v[16:31], v[60:63], v[56:59], v[16:31]
    s_waitcnt lgkmcnt(6)
    v_mfma_f32_32x32x16_bf16 v[16:31], v[68:71], v[64:67], v[16:31]
    s_waitcnt lgkmcnt(4)
    ds_read_b128 v[48:51], v110 offset:20480
    ds_read_b128 v[52:55], v5 offset:640
    ds_read_b128 v[56:59], v4 offset:20480
    ds_read_b128 v[60:63], v5 offset:672
    v_mfma_f32_32x32x16_bf16 v[16:31], v[76:79], v[72:75], v[16:31]
    s_waitcnt lgkmcnt(6)
    v_mfma_f32_32x32x16_bf16 v[16:31], v[36:39], v[32:35], v[16:31]
    s_waitcnt lgkmcnt(4)
    ds_read_b128 v[64:67], v110 offset:22528
    ds_read_b128 v[68:71], v5 offset:704
    ds_read_b128 v[72:75], v4 offset:22528
    ds_read_b128 v[76:79], v5 offset:736
    v_mfma_f32_32x32x16_bf16 v[16:31], v[44:47], v[40:43], v[16:31]
    s_waitcnt lgkmcnt(6)
    v_mfma_f32_32x32x16_bf16 v[16:31], v[52:55], v[48:51], v[16:31]
    s_waitcnt lgkmcnt(4)
    ds_read_b128 v[32:35], v110 offset:24576
    ds_read_b128 v[36:39], v5 offset:768
    ds_read_b128 v[40:43], v4 offset:24576
    ds_read_b128 v[44:47], v5 offset:800
    v_mfma_f32_32x32x16_bf16 v[16:31], v[60:63], v[56:59], v[16:31]
    s_waitcnt lgkmcnt(6)
    v_mfma_f32_32x32x16_bf16 v[16:31], v[68:71], v[64:67], v[16:31]
    s_waitcnt lgkmcnt(4)
    ds_read_b128 v[48:51], v110 offset:26624
    ds_read_b128 v[52:55], v5 offset:832
    ds_read_b128 v[56:59], v4 offset:26624
    ds_read_b128 v[60:63], v5 offset:864
    v_mfma_f32_32x32x16_bf16 v[16:31], v[76:79], v[72:75], v[16:31]
    s_waitcnt lgkmcnt(6)
    v_mfma_f32_32x32x16_bf16 v[16:31], v[36:39], v[32:35], v[16:31]
    s_waitcnt lgkmcnt(4)
    ds_read_b128 v[64:67], v110 offset:28672
    ds_read_b128 v[68:71], v5 offset:896
    ds_read_b128 v[72:75], v4 offset:28672
    ds_read_b128 v[76:79], v5 offset:928
    v_mfma_f32_32x32x16_bf16 v[16:31], v[44:47], v[40:43], v[16:31]
    s_waitcnt lgkmcnt(6)
    v_mfma_f32_32x32x16_bf16 v[16:31], v[52:55], v[48:51], v[16:31]
    s_waitcnt lgkmcnt(4)
    ds_read_b128 v[32:35], v110 offset:30720
    ds_read_b128 v[36:39], v5 offset:960
    ds_read_b128 v[40:43], v4 offset:30720
    ds_read_b128 v[44:47], v5 offset:992
    v_mfma_f32_32x32x16_bf16 v[16:31], v[60:63], v[56:59], v[16:31]
    s_waitcnt lgkmcnt(6)
    v_mfma_f32_32x32x16_bf16 v[16:31], v[68:71], v[64:67], v[16:31]
    s_waitcnt lgkmcnt(4)
    ds_read_b128 v[48:51], v110 offset:32768
    ds_read_b128 v[52:55], v5 offset:1024
    ds_read_b128 v[56:59], v4 offset:32768
    ds_read_b128 v[60:63], v5 offset:1056
    v_mfma_f32_32x32x16_bf16 v[16:31], v[76:79], v[72:75], v[16:31]
    s_waitcnt lgkmcnt(6)
    v_mfma_f32_32x32x16_bf16 v[16:31], v[36:39], v[32:35], v[16:31]
    s_waitcnt lgkmcnt(4)
    ds_read_b128 v[64:67], v110 offset:34816
    ds_read_b128 v[68:71], v5 offset:1088
    ds_read_b128 v[72:75], v4 offset:34816
    ds_read_b128 v[76:79], v5 offset:1120
    v_mfma_f32_32x32x16_bf16 v[16:31], v[44:47], v[40:43], v[16:31]
    s_waitcnt lgkmcnt(6)
    v_mfma_f32_32x32x16_bf16 v[16:31], v[52:55], v[48:51], v[16:31]
    s_waitcnt lgkmcnt(4)
    v_mfma_f32_32x32x16_bf16 v[16:31], v[60:63], v[56:59], v[16:31]
    s_waitcnt lgkmcnt(2)
    v_mfma_f32_32x32x16_bf16 v[16:31], v[68:71], v[64:67], v[16:31]
    s_waitcnt lgkmcnt(0)
    v_mfma_f32_32x32x16_bf16 v[16:31], v[76:79], v[72:75], v[16:31]
    s_nop 11
    v_mul_f32 v4, 3216550459, v16
    v_exp_f32 v4, v4
    s_nop 0
    v_add_f32 v4, 1.0, v4
    v_rcp_f32 v4, v4
    s_nop 0
    ds_write_b32 v6, v4
    s_branch f_a0
f_b0:
    s_lshr_b32 s74, s58, 1
    s_lshl_b32 s74, s74, 2
    s_add_u32 s74, s74, s72
    s_setprio 1
    v_and_b32 v4, 3, v1
    v_bfe_u32 v5, v1, 2, 1
    v_lshl_add_u32 v4, v5, 3, v4
    v_bfe_u32 v5, v1, 3, 1
    v_lshl_add_u32 v4, v5, 2, v4
    s_lshl_b32 s3, s74, 4
    v_add_u32 v4, s3, v4
    s_cmp_eq_u32 s74, 0
    s_cselect_b32 s6, 0x10000, 0
    s_mov_b32 s7, s6
    v_mov_b32 v5, 288
    v_cndmask_b32 v4, v4, v5, s[6:7]
    s_or_b32 s6, s6, 0xffff
    s_mov_b32 s7, s6
    v_mov_b32 v5, 144
    v_cndmask_b32 v5, v5, 0, s[6:7]
    v_lshrrev_b32 v6, 5, v1
    v_lshlrev_b32 v6, 3, v6
    s_lshl_b32 s3, s67, 6
    v_add_u32 v6, s3, v6
    v_mad_u32_u24 v5, v4, v6, v5
    s_mov_b32 s6, 7456541
    s_mov_b32 s7, 987991609
    v_mul_hi_u32 v8, v5, s6
    v_mul_u32_u24 v8, 576, v8
    v_sub_u32 v8, v5, v8
    v_cvt_f32_u32 v8, v8
    v_mul_f32 v8, s7, v8
    v_cos_f32 v16, v8
    v_add_u32 v5, v5, v4
    v_mul_hi_u32 v8, v5, s6
    v_mul_u32_u24 v8, 576, v8
    v_sub_u32 v8, v5, v8
    v_cvt_f32_u32 v8, v8
    v_mul_f32 v8, s7, v8
    v_cos_f32 v17, v8
    v_mul_u32_u24 v6, 15, v4
    v_add_u32 v5, v5, v6
    v_mul_hi_u32 v8, v5, s6
    v_mul_u32_u24 v8, 576, v8
    v_sub_u32 v8, v5, v8
    v_cvt_f32_u32 v8, v8
    v_mul_f32 v8, s7, v8
    v_cos_f32 v24, v8
    v_add_u32 v5, v5, v4
    v_mul_hi_u32 v8, v5, s6
    v_mul_u32_u24 v8, 576, v8
    v_sub_u32 v8, v5, v8
    v_cvt_f32_u32 v8, v8
    v_mul_f32 v8, s7, v8
    v_cos_f32 v25, v8
    v_mul_hi_u32 v8, v4, s6
    v_mul_u32_u24 v8, 576, v8
    v_sub_u32 v8, v4, v8
    v_cvt_f32_u32 v8, v8
    v_mul_f32 v8, s7, v8
    v_cos_f32 v7, v8
    v_lshlrev_b32 v6, 4, v4
    v_add_f32 v7, v7, v7
    v_mul_hi_u32 v8, v6, s6
    v_mul_u32_u24 v8, 576, v8
    v_sub_u32 v8, v6, v8
    v_cvt_f32_u32 v8, v8
    v_mul_f32 v8, s7, v8
    v_cos_f32 v6, v8
    v_fma_f32 v18, v7, v17, -v16
    v_fma_f32 v26, v7, v25, -v24
    v_fma_f32 v19, v7, v18, -v17
    v_fma_f32 v27, v7, v26, -v25
    v_fma_f32 v20, v7, v19, -v18
    v_fma_f32 v28, v7, v27, -v26
    v_fma_f32 v21, v7, v20, -v19
    v_fma_f32 v29, v7, v28, -v27
    v_fma_f32 v22, v7, v21, -v20
    v_fma_f32 v30, v7, v29, -v28
    v_fma_f32 v23, v7, v22, -v21
    v_fma_f32 v31, v7, v30, -v29
    v_add_f32 v6, v6, v6
    v_lshlrev_b32 v4, 31, v4
    v_or_b32 v4, 1.0, v4
    v_xor_b32 v8, 32, v110
    v_cvt_pk_bf16_f32 v72, v16, v17
    v_cvt_pk_bf16_f32 v73, v18, v19
    v_cvt_pk_bf16_f32 v74, v20, v21
    v_cvt_pk_bf16_f32 v75, v22, v23
    v_fma_f32 v16, v6, v24, -v16
    v_fma_f32 v17, v6, v25, -v17
    v_fma_f32 v18, v6, v26, -v18
    v_fma_f32 v19, v6, v27, -v19
    v_fma_f32 v20, v6, v28, -v20
    v_fma_f32 v21, v6, v29, -v21
    v_fma_f32 v22, v6, v30, -v22
    v_fma_f32 v23, v6, v31, -v23
    v_cvt_pk_bf16_f32 v76, v24, v25
    v_cvt_pk_bf16_f32 v77, v26, v27
    v_cvt_pk_bf16_f32 v78, v28, v29
    v_cvt_pk_bf16_f32 v79, v30, v31
    v_fma_f32 v24, v6, v16, -v24
    v_fma_f32 v25, v6, v17, -v25
    v_fma_f32 v26, v6, v18, -v26
    v_fma_f32 v27, v6, v19, -v27
    v_fma_f32 v28, v6, v20, -v28
    v_fma_f32 v29, v6, v21, -v29
    v_fma_f32 v30, v6, v22, -v30
    v_fma_f32 v31, v6, v23, -v31
    v_cvt_pk_bf16_f32 v80, v16, v17
    v_cvt_pk_bf16_f32 v81, v18, v19
    v_cvt_pk_bf16_f32 v82, v20, v21
    v_cvt_pk_bf16_f32 v83, v22, v23
    v_fma_f32 v16, v6, v24, -v16
    v_fma_f32 v17, v6, v25, -v17
    v_fma_f32 v18, v6, v26, -v18
    v_fma_f32 v19, v6, v27, -v19
    v_fma_f32 v20, v6, v28, -v20
    v_fma_f32 v21, v6, v29, -v21
    v_fma_f32 v22, v6, v30, -v22
    v_fma_f32 v23, v6, v31, -v23
    v_cvt_pk_bf16_f32 v84, v24, v25
    v_cvt_pk_bf16_f32 v85, v26, v27
    v_cvt_pk_bf16_f32 v86, v28, v29
    v_cvt_pk_bf16_f32 v87, v30, v31
    v_fma_f32 v24, v6, v16, -v24
    v_fma_f32 v25, v6, v17, -v25
    v_fma_f32 v26, v6, v18, -v26
    v_fma_f32 v27, v6, v19, -v27
    v_fma_f32 v28, v6, v20, -v28
    v_fma_f32 v29, v6, v21, -v29
    v_fma_f32 v30, v6, v22, -v30
    v_fma_f32 v31, v6, v23, -v31
    v_cvt_pk_bf16_f32 v88, v16, v17
    v_cvt_pk_bf16_f32 v89, v18, v19
    v_cvt_pk_bf16_f32 v90, v20, v21
    v_cvt_pk_bf16_f32 v91, v22, v23
    v_fma_f32 v16, v6, v24, -v16
    v_fma_f32 v17, v6, v25, -v17
    v_fma_f32 v18, v6, v26, -v18
    v_fma_f32 v19, v6, v27, -v19
    v_fma_f32 v20, v6, v28, -v20
    v_fma_f32 v21, v6, v29, -v21
    v_fma_f32 v22, v6, v30, -v22
    v_fma_f32 v23, v6, v31, -v23
    v_cvt_pk_bf16_f32 v92, v24, v25
    v_cvt_pk_bf16_f32 v93, v26, v27
    v_cvt_pk_bf16_f32 v94, v28, v29
    v_cvt_pk_bf16_f32 v95, v30, v31
    v_fma_f32 v24, v6, v16, -v24
    v_fma_f32 v25, v6, v17, -v25
    v_fma_f32 v26, v6, v18, -v26
    v_fma_f32 v27, v6, v19, -v27
    v_fma_f32 v28, v6, v20, -v28
    v_fma_f32 v29, v6, v21, -v29
    v_fma_f32 v30, v6, v22, -v30
    v_fma_f32 v31, v6, v23, -v31
    v_cvt_pk_bf16_f32 v96, v16, v17
    v_cvt_pk_bf16_f32 v97, v18, v19
    v_cvt_pk_bf16_f32 v98, v20, v21
    v_cvt_pk_bf16_f32 v99, v22, v23
    v_fma_f32 v16, v6, v24, -v16
    v_fma_f32 v17, v6, v25, -v17
    v_fma_f32 v18, v6, v26, -v18
    v_fma_f32 v19, v6, v27, -v19
    v_fma_f32 v20, v6, v28, -v20
    v_fma_f32 v21, v6, v29, -v21
    v_fma_f32 v22, v6, v30, -v22
    v_fma_f32 v23, v6, v31, -v23
    v_cvt_pk_bf16_f32 v100, v24, v25
    v_cvt_pk_bf16_f32 v101, v26, v27
    v_cvt_pk_bf16_f32 v102, v28, v29
    v_cvt_pk_bf16_f32 v103, v30, v31
    v_fma_f32 v24, v6, v16, -v24
    v_fma_f32 v25, v6, v17, -v25
    v_fma_f32 v26, v6, v18, -v26
    v_fma_f32 v27, v6, v19, -v27
    v_fma_f32 v28, v6, v20, -v28
    v_fma_f32 v29, v6, v21, -v29
    v_fma_f32 v30, v6, v22, -v30
    v_fma_f32 v31, v6, v23, -v31
    v_cvt_pk_bf16_f32 v104, v16, v17
    v_cvt_pk_bf16_f32 v105, v18, v19
    v_cvt_pk_bf16_f32 v106, v20, v21
    v_cvt_pk_bf16_f32 v107, v22, v23
    v_fma_f32 v16, v6, v24, -v16
    v_fma_f32 v17, v6, v25, -v17
    v_fma_f32 v18, v6, v26, -v18
    v_fma_f32 v19, v6, v27, -v19
    v_fma_f32 v20, v6, v28, -v20
    v_fma_f32 v21, v6, v29, -v21
    v_fma_f32 v22, v6, v30, -v22
    v_fma_f32 v23, v6, v31, -v23
    v_cvt_pk_bf16_f32 v132, v24, v25
    v_cvt_pk_bf16_f32 v133, v26, v27
    v_cvt_pk_bf16_f32 v134, v28, v29
    v_cvt_pk_bf16_f32 v135, v30, v31
    v_fma_f32 v24, v6, v16, -v24
    v_fma_f32 v25, v6, v17, -v25
    v_fma_f32 v26, v6, v18, -v26
    v_fma_f32 v27, v6, v19, -v27
    v_fma_f32 v28, v6, v20, -v28
    v_fma_f32 v29, v6, v21, -v29
    v_fma_f32 v30, v6, v22, -v30
    v_fma_f32 v31, v6, v23, -v31
    v_cvt_pk_bf16_f32 v136, v16, v17
    v_cvt_pk_bf16_f32 v137, v18, v19
    v_cvt_pk_bf16_f32 v138, v20, v21
    v_cvt_pk_bf16_f32 v139, v22, v23
    v_fma_f32 v16, v6, v24, -v16
    v_fma_f32 v17, v6, v25, -v17
    v_fma_f32 v18, v6, v26, -v18
    v_fma_f32 v19, v6, v27, -v19
    v_fma_f32 v20, v6, v28, -v20
    v_fma_f32 v21, v6, v29, -v21
    v_fma_f32 v22, v6, v30, -v22
    v_fma_f32 v23, v6, v31, -v23
    v_cvt_pk_bf16_f32 v140, v24, v25
    v_cvt_pk_bf16_f32 v141, v26, v27
    v_cvt_pk_bf16_f32 v142, v28, v29
    v_cvt_pk_bf16_f32 v143, v30, v31
    v_fma_f32 v24, v6, v16, -v24
    v_fma_f32 v25, v6, v17, -v25
    v_fma_f32 v26, v6, v18, -v26
    v_fma_f32 v27, v6, v19, -v27
    v_fma_f32 v28, v6, v20, -v28
    v_fma_f32 v29, v6, v21, -v29
    v_fma_f32 v30, v6, v22, -v30
    v_fma_f32 v31, v6, v23, -v31
    v_cvt_pk_bf16_f32 v144, v16, v17
    v_cvt_pk_bf16_f32 v145, v18, v19
    v_cvt_pk_bf16_f32 v146, v20, v21
    v_cvt_pk_bf16_f32 v147, v22, v23
    v_fma_f32 v16, v6, v24, -v16
    v_fma_f32 v17, v6, v25, -v17
    v_fma_f32 v18, v6, v26, -v18
    v_fma_f32 v19, v6, v27, -v19
    v_fma_f32 v20, v6, v28, -v20
    v_fma_f32 v21, v6, v29, -v21
    v_fma_f32 v22, v6, v30, -v22
    v_fma_f32 v23, v6, v31, -v23
    v_cvt_pk_bf16_f32 v148, v24, v25
    v_cvt_pk_bf16_f32 v149, v26, v27
    v_cvt_pk_bf16_f32 v150, v28, v29
    v_cvt_pk_bf16_f32 v151, v30, v31
    v_fma_f32 v24, v6, v16, -v24
    v_fma_f32 v25, v6, v17, -v25
    v_fma_f32 v26, v6, v18, -v26
    v_fma_f32 v27, v6, v19, -v27
    v_fma_f32 v28, v6, v20, -v28
    v_fma_f32 v29, v6, v21, -v29
    v_fma_f32 v30, v6, v22, -v30
    v_fma_f32 v31, v6, v23, -v31
    v_cvt_pk_bf16_f32 v152, v16, v17
    v_cvt_pk_bf16_f32 v153, v18, v19
    v_cvt_pk_bf16_f32 v154, v20, v21
    v_cvt_pk_bf16_f32 v155, v22, v23
    v_fma_f32 v16, v6, v24, -v16
    v_fma_f32 v17, v6, v25, -v17
    v_fma_f32 v18, v6, v26, -v18
    v_fma_f32 v19, v6, v27, -v19
    v_fma_f32 v20, v6, v28, -v20
    v_fma_f32 v21, v6, v29, -v21
    v_fma_f32 v22, v6, v30, -v22
    v_fma_f32 v23, v6, v31, -v23
    v_cvt_pk_bf16_f32 v156, v24, v25
    v_cvt_pk_bf16_f32 v157, v26, v27
    v_cvt_pk_bf16_f32 v158, v28, v29
    v_cvt_pk_bf16_f32 v159, v30, v31
    v_fma_f32 v24, v6, v16, -v24
    v_fma_f32 v25, v6, v17, -v25
    v_fma_f32 v26, v6, v18, -v26
    v_fma_f32 v27, v6, v19, -v27
    v_fma_f32 v28, v6, v20, -v28
    v_fma_f32 v29, v6, v21, -v29
    v_fma_f32 v30, v6, v22, -v30
    v_fma_f32 v31, v6, v23, -v31
    v_cvt_pk_bf16_f32 v160, v16, v17
    v_cvt_pk_bf16_f32 v161, v18, v19
    v_cvt_pk_bf16_f32 v162, v20, v21
    v_cvt_pk_bf16_f32 v163, v22, v23
    v_cvt_pk_bf16_f32 v164, v24, v25
    v_cvt_pk_bf16_f32 v165, v26, v27
    v_cvt_pk_bf16_f32 v166, v28, v29
    v_cvt_pk_bf16_f32 v167, v30, v31
    s_branch f_j1
f_j1_z:
    s_sleep 1
f_j1:
    ds_read_b32 v5, v108
    s_waitcnt lgkmcnt(0)
    v_cmp_gt_i32 vcc, 3, v5
    s_cbranch_vccnz f_j1_z
    ds_read_b128 v[48:51], v110 offset:0
    ds_read_b128 v[52:55], v8 offset:0
    ds_read_b128 v[56:59], v110 offset:2048
    ds_read_b128 v[60:63], v8 offset:2048
    ds_read_b128 v[64:67], v110 offset:4096
    ds_read_b128 v[68:71], v8 offset:4096
    ds_read_b128 v[116:119], v110 offset:6144
    ds_read_b128 v[120:123], v8 offset:6144
    ds_read_b128 v[124:127], v110 offset:8192
    s_waitcnt lgkmcnt(8)
    v_mfma_f32_32x32x16_bf16 v[16:31], v[48:51], v[72:75], 0
    ds_read_b128 v[48:51], v8 offset:8192
    s_waitcnt lgkmcnt(8)
    v_mfma_f32_32x32x16_bf16 v[16:31], v[52:55], v[76:79], v[16:31]
    ds_read_b128 v[52:55], v110 offset:10240
    s_waitcnt lgkmcnt(8)
    v_mfma_f32_32x32x16_bf16 v[16:31], v[56:59], v[80:83], v[16:31]
    ds_read_b128 v[56:59], v8 offset:10240
    s_waitcnt lgkmcnt(8)
    v_mfma_f32_32x32x16_bf16 v[16:31], v[60:63], v[84:87], v[16:31]
    ds_read_b32 v5, v108
    ds_read_b128 v[60:63], v110 offset:12288
    s_waitcnt lgkmcnt(9)
    v_mfma_f32_32x32x16_bf16 v[16:31], v[64:67], v[88:91], v[16:31]
    ds_read_b128 v[64:67], v8 offset:12288
    s_waitcnt lgkmcnt(9)
    v_mfma_f32_32x32x16_bf16 v[16:31], v[68:71], v[92:95], v[16:31]
    ds_read_b128 v[68:71], v110 offset:14336
    s_waitcnt lgkmcnt(9)
    v_mfma_f32_32x32x16_bf16 v[16:31], v[116:119], v[96:99], v[16:31]
    ds_read_b128 v[116:119], v8 offset:14336
    s_waitcnt lgkmcnt(9)
    v_mfma_f32_32x32x16_bf16 v[16:31], v[120:123], v[100:103], v[16:31]
    ds_read_b128 v[120:123], v110 offset:16384
    s_waitcnt lgkmcnt(9)
    v_mfma_f32_32x32x16_bf16 v[16:31], v[124:127], v[104:107], v[16:31]
    ds_read_b128 v[124:127], v8 offset:16384
    s_waitcnt lgkmcnt(9)
    v_mfma_f32_32x32x16_bf16 v[16:31], v[48:51], v[132:135], v[16:31]
    s_waitcnt lgkmcnt(8)
    v_mfma_f32_32x32x16_bf16 v[16:31], v[52:55], v[136:139], v[16:31]
    s_waitcnt lgkmcnt(7)
    v_mfma_f32_32x32x16_bf16 v[16:31], v[56:59], v[140:143], v[16:31]
    s_waitcnt lgkmcnt(5)
    v_mfma_f32_32x32x16_bf16 v[16:31], v[60:63], v[144:147], v[16:31]
    s_waitcnt lgkmcnt(4)
    v_mfma_f32_32x32x16_bf16 v[16:31], v[64:67], v[148:151], v[16:31]
    s_waitcnt lgkmcnt(3)
    v_mfma_f32_32x32x16_bf16 v[16:31], v[68:71], v[152:155], v[16:31]
    v_cmp_gt_i32 vcc, 6, v5
    s_cbranch_vccz f_j2_ok
f_j2:
    ds_read_b32 v5, v108
    s_waitcnt lgkmcnt(0)
    v_cmp_gt_i32 vcc, 6, v5
    s_cbranch_vccnz f_j2
f_j2_ok:
    ds_read_b128 v[48:51], v110 offset:18432
    ds_read_b128 v[52:55], v8 offset:18432
    ds_read_b128 v[56:59], v110 offset:20480
    ds_read_b128 v[60:63], v8 offset:20480
    ds_read_b128 v[64:67], v110 offset:22528
    ds_read_b128 v[68:71], v8 offset:22528
    s_waitcnt lgkmcnt(8)
    v_mfma_f32_32x32x16_bf16 v[16:31], v[116:119], v[156:159], v[16:31]
    ds_read_b128 v[116:119], v110 offset:24576
    s_waitcnt lgkmcnt(8)
    v_mfma_f32_32x32x16_bf16 v[16:31], v[120:123], v[160:163], v[16:31]
    ds_read_b128 v[120:123], v8 offset:24576
    s_waitcnt lgkmcnt(8)
    v_mfma_f32_32x32x16_bf16 v[16:31], v[124:127], v[164:167], v[16:31]
    ds_read_b128 v[124:127], v110 offset:26624
    s_waitcnt lgkmcnt(8)
    v_mfma_f32_32x32x16_bf16 v[32:47], v[48:51], v[72:75], 0
    ds_read_b128 v[48:51], v8 offset:26624
    ds_read_b128 v[72:75], v110 offset:28672
    s_waitcnt lgkmcnt(9)
    v_mfma_f32_32x32x16_bf16 v[32:47], v[52:55], v[76:79], v[32:47]
    ds_read_b128 v[52:55], v8 offset:28672
    ds_read_b128 v[76:79], v110 offset:30720
    s_waitcnt lgkmcnt(10)
    v_mfma_f32_32x32x16_bf16 v[32:47], v[56:59], v[80:83], v[32:47]
    ds_read_b128 v[56:59], v8 offset:30720
    ds_read_b128 v[80:83], v110 offset:32768
    s_waitcnt lgkmcnt(11)
    v_mfma_f32_32x32x16_bf16 v[32:47], v[60:63], v[84:87], v[32:47]
    ds_read_b128 v[60:63], v8 offset:32768
    ds_read_b128 v[84:87], v110 offset:34816
    s_waitcnt lgkmcnt(12)
    v_mfma_f32_32x32x16_bf16 v[32:47], v[64:67], v[88:91], v[32:47]
    ds_read_b128 v[64:67], v8 offset:34816
    s_waitcnt lgkmcnt(12)
    v_mfma_f32_32x32x16_bf16 v[32:47], v[68:71], v[92:95], v[32:47]
    s_waitcnt lgkmcnt(11)
    v_mfma_f32_32x32x16_bf16 v[32:47], v[116:119], v[96:99], v[32:47]
    s_waitcnt lgkmcnt(10)
    v_mfma_f32_32x32x16_bf16 v[32:47], v[120:123], v[100:103], v[32:47]
    s_waitcnt lgkmcnt(9)
    v_mfma_f32_32x32x16_bf16 v[32:47], v[124:127], v[104:107], v[32:47]
    s_waitcnt lgkmcnt(8)
    v_mfma_f32_32x32x16_bf16 v[32:47], v[48:51], v[132:135], v[32:47]
    s_waitcnt lgkmcnt(7)
    v_mfma_f32_32x32x16_bf16 v[32:47], v[72:75], v[136:139], v[32:47]
    s_waitcnt lgkmcnt(6)
    v_mfma_f32_32x32x16_bf16 v[32:47], v[52:55], v[140:143], v[32:47]
    s_waitcnt lgkmcnt(5)
    v_mfma_f32_32x32x16_bf16 v[32:47], v[76:79], v[144:147], v[32:47]
    s_getpc_b64 s[4:5]
f_jrf:
    s_add_u32 s4, s4, rf_table-f_jrf
    s_addc_u32 s5, s5, 0
    v_lshlrev_b32 v5, 4, v1
    global_load_dwordx4 v[132:135], v5, s[4:5] offset:0
    global_load_dwordx4 v[136:139], v5, s[4:5] offset:1024
    global_load_dwordx4 v[140:143], v5, s[4:5] offset:2048
    global_load_dwordx4 v[144:147], v5, s[4:5] offset:3072
    s_waitcnt lgkmcnt(4)
    v_mfma_f32_32x32x16_bf16 v[32:47], v[56:59], v[148:151], v[32:47]
    s_waitcnt lgkmcnt(3)
    v_mfma_f32_32x32x16_bf16 v[32:47], v[80:83], v[152:155], v[32:47]
    s_waitcnt lgkmcnt(2)
    v_mfma_f32_32x32x16_bf16 v[32:47], v[60:63], v[156:159], v[32:47]
    s_waitcnt lgkmcnt(1)
    v_mfma_f32_32x32x16_bf16 v[32:47], v[84:87], v[160:163], v[32:47]
    s_waitcnt lgkmcnt(0)
    v_mfma_f32_32x32x16_bf16 v[32:47], v[64:67], v[164:167], v[32:47]
    s_nop 11
    v_fmac_f32 v16, v4, v32
    v_fmac_f32 v17, v4, v33
    v_fmac_f32 v18, v4, v34
    v_fmac_f32 v19, v4, v35
    v_fmac_f32 v20, v4, v36
    v_fmac_f32 v21, v4, v37
    v_fmac_f32 v22, v4, v38
    v_fmac_f32 v23, v4, v39
    v_fmac_f32 v24, v4, v40
    v_fmac_f32 v25, v4, v41
    v_fmac_f32 v26, v4, v42
    v_fmac_f32 v27, v4, v43
    v_fmac_f32 v28, v4, v44
    v_fmac_f32 v29, v4, v45
    v_fmac_f32 v30, v4, v46
    v_fmac_f32 v31, v4, v47
    v_cvt_pk_bf16_f32 v116, v16, v17
    v_cvt_pk_bf16_f32 v117, v18, v19
    v_cvt_pk_bf16_f32 v118, v20, v21
    v_cvt_pk_bf16_f32 v119, v22, v23
    v_cvt_pk_bf16_f32 v120, v24, v25
    v_cvt_pk_bf16_f32 v121, v26, v27
    v_cvt_pk_bf16_f32 v122, v28, v29
    v_cvt_pk_bf16_f32 v123, v30, v31
    s_waitcnt vmcnt(0)
    v_mfma_f32_32x32x16_bf16 v[32:47], v[116:119], v[132:135], 0
    v_mfma_f32_32x32x16_bf16 v[64:79], v[116:119], v[140:143], 0
    v_mfma_f32_32x32x16_bf16 v[32:47], v[120:123], v[136:139], v[32:47]
    v_mfma_f32_32x32x16_bf16 v[64:79], v[120:123], v[144:147], v[64:79]
    s_cmp_eq_u32 s74, 0
    s_cselect_b32 s6, -1, 0
    s_mov_b32 s7, 0
    s_nop 8
    v_cvt_pk_bf16_f32 v130, v40, v72
    v_cndmask_b32 v40, v40, 0, s[6:7]
    v_cndmask_b32 v72, v72, 0, s[6:7]
    v_add_f32 v80, v32, v72
    v_add_f32 v81, v33, v73
    v_add_f32 v82, v34, v74
    v_add_f32 v83, v35, v75
    v_add_f32 v84, v36, v76
    v_add_f32 v85, v37, v77
    v_add_f32 v86, v38, v78
    v_add_f32 v87, v39, v79
    v_cvt_pk_bf16_f32 v116, v80, v81
    v_cvt_pk_bf16_f32 v117, v82, v83
    v_cvt_pk_bf16_f32 v118, v84, v85
    v_cvt_pk_bf16_f32 v119, v86, v87
    v_sub_f32 v80, v64, v40
    v_sub_f32 v81, v65, v41
    v_sub_f32 v82, v66, v42
    v_sub_f32 v83, v67, v43
    v_sub_f32 v84, v68, v44
    v_sub_f32 v85, v69, v45
    v_sub_f32 v86, v70, v46
    v_sub_f32 v87, v71, v47
    v_cvt_pk_bf16_f32 v120, v80, v81
    v_cvt_pk_bf16_f32 v121, v82, v83
    v_cvt_pk_bf16_f32 v122, v84, v85
    v_cvt_pk_bf16_f32 v123, v86, v87
    v_sub_f32 v80, v32, v72
    v_sub_f32 v81, v33, v73
    v_sub_f32 v82, v34, v74
    v_sub_f32 v83, v35, v75
    v_sub_f32 v84, v36, v76
    v_sub_f32 v85, v37, v77
    v_sub_f32 v86, v38, v78
    v_sub_f32 v87, v39, v79
    v_cvt_pk_bf16_f32 v124, v87, v86
    v_cvt_pk_bf16_f32 v125, v85, v84
    v_cvt_pk_bf16_f32 v126, v83, v82
    v_cvt_pk_bf16_f32 v127, v81, v80
    v_add_f32 v80, v64, v40
    v_add_f32 v81, v65, v41
    v_add_f32 v82, v66, v42
    v_add_f32 v83, v67, v43
    v_add_f32 v84, v68, v44
    v_add_f32 v85, v69, v45
    v_add_f32 v86, v70, v46
    v_add_f32 v87, v71, v47
    v_cvt_pk_bf16_f32 v132, v87, v86
    v_cvt_pk_bf16_f32 v133, v85, v84
    v_cvt_pk_bf16_f32 v134, v83, v82
    v_cvt_pk_bf16_f32 v135, v81, v80
f_a0:
f_q0:
    ds_read_b32 v2, v108
    s_waitcnt lgkmcnt(0)
    v_cmp_gt_i32 vcc, 7, v2
    s_cbranch_vccnz f_q0
    s_add_u32 s54, s54, 1
    ds_read_b64_tr_b16 v[64:65], v113 offset:0
    ds_read_b64_tr_b16 v[66:67], v113 offset:144
    ds_read_b128 v[68:71], v111 offset:0
    ds_read_b64_tr_b16 v[72:73], v113 offset:2304
    ds_read_b64_tr_b16 v[74:75], v113 offset:2448
    ds_read_b128 v[76:79], v112 offset:0
    ds_read_b64_tr_b16 v[80:81], v113 offset:4608
    ds_read_b64_tr_b16 v[82:83], v113 offset:4752
    ds_read_b128 v[84:87], v111 offset:2048
    ds_read_b64_tr_b16 v[88:89], v113 offset:6912
    ds_read_b64_tr_b16 v[90:91], v113 offset:7056
    ds_read_b128 v[92:95], v112 offset:2048
    s_waitcnt lgkmcnt(9)
    v_mfma_f32_32x32x16_bf16 v[32:47], v[64:67], v[68:71], 0
    v_cmp_gt_i32 vcc, 8, v2
    s_cbranch_vccz f_q1_ok
f_q1:
    ds_read_b32 v2, v108
    s_waitcnt lgkmcnt(0)
    v_cmp_gt_i32 vcc, 8, v2
    s_cbranch_vccnz f_q1
f_q1_ok:
    ds_read_b64_tr_b16 v[96:97], v113 offset:9216
    ds_read_b64_tr_b16 v[98:99], v113 offset:9360
    ds_read_b128 v[100:103], v111 offset:4096
    s_waitcnt lgkmcnt(9)
    v_mfma_f32_32x32x16_bf16 v[32:47], v[72:75], v[76:79], v[32:47]
    ds_read_b64_tr_b16 v[64:65], v113 offset:11520
    ds_read_b64_tr_b16 v[66:67], v113 offset:11664
    ds_read_b128 v[68:71], v112 offset:4096
    s_waitcnt lgkmcnt(9)
    v_mfma_f32_32x32x16_bf16 v[32:47], v[80:83], v[84:87], v[32:47]
    ds_read_b32 v2, v108
    ds_read_b64_tr_b16 v[72:73], v113 offset:13824
    ds_read_b64_tr_b16 v[74:75], v113 offset:13968
    ds_read_b128 v[76:79], v111 offset:6144
    s_waitcnt lgkmcnt(10)
    v_mfma_f32_32x32x16_bf16 v[32:47], v[88:91], v[92:95], v[32:47]
    ds_read_b64_tr_b16 v[80:81], v113 offset:16128
    ds_read_b64_tr_b16 v[82:83], v113 offset:16272
    ds_read_b128 v[84:87], v112 offset:6144
    s_waitcnt lgkmcnt(10)
    v_mfma_f32_32x32x16_bf16 v[32:47], v[96:99], v[100:103], v[32:47]
    s_waitcnt lgkmcnt(6)
    v_cmp_gt_i32 vcc, 9, v2
    s_cbranch_vccz f_q2_ok
f_q2:
    ds_read_b32 v2, v108
    s_waitcnt lgkmcnt(0)
    v_cmp_gt_i32 vcc, 9, v2
    s_cbranch_vccnz f_q2
f_q2_ok:
    ds_read_b64_tr_b16 v[88:89], v113 offset:18432
    ds_read_b64_tr_b16 v[90:91], v113 offset:18576
    ds_read_b128 v[92:95], v111 offset:8192
    v_mfma_f32_32x32x16_bf16 v[32:47], v[64:67], v[68:71], v[32:47]
    ds_read_b64_tr_b16 v[96:97], v113 offset:20736
    ds_read_b64_tr_b16 v[98:99], v113 offset:20880
    ds_read_b128 v[100:103], v112 offset:8192
    s_waitcnt lgkmcnt(9)
    v_mfma_f32_32x32x16_bf16 v[32:47], v[72:75], v[76:79], v[32:47]
    ds_read_b32 v2, v108
    ds_read_b64_tr_b16 v[64:65], v113 offset:23040
    ds_read_b64_tr_b16 v[66:67], v113 offset:23184
    ds_read_b128 v[68:71], v111 offset:10240
    s_waitcnt lgkmcnt(10)
    v_mfma_f32_32x32x16_bf16 v[32:47], v[80:83], v[84:87], v[32:47]
    v_mov_b32 v3, 1
    ds_write_b32 v109, v3
    ds_read_b64_tr_b16 v[72:73], v113 offset:25344
    ds_read_b64_tr_b16 v[74:75], v113 offset:25488
    ds_read_b128 v[76:79], v112 offset:10240
    s_waitcnt lgkmcnt(11)
    v_mfma_f32_32x32x16_bf16 v[32:47], v[88:91], v[92:95], v[32:47]
    s_waitcnt lgkmcnt(7)
    v_cmp_gt_i32 vcc, 10, v2
    s_cbranch_vccz f_q3_ok
f_q3:
    ds_read_b32 v2, v108
    s_waitcnt lgkmcnt(0)
    v_cmp_gt_i32 vcc, 10, v2
    s_cbranch_vccnz f_q3
f_q3_ok:
    ds_read_b64_tr_b16 v[80:81], v113 offset:27648
    ds_read_b64_tr_b16 v[82:83], v113 offset:27792
    ds_read_b128 v[84:87], v111 offset:12288
    v_mfma_f32_32x32x16_bf16 v[32:47], v[96:99], v[100:103], v[32:47]
    ds_read_b64_tr_b16 v[88:89], v113 offset:29952
    ds_read_b64_tr_b16 v[90:91], v113 offset:30096
    ds_read_b128 v[92:95], v112 offset:12288
    s_waitcnt lgkmcnt(10)
    v_mfma_f32_32x32x16_bf16 v[32:47], v[64:67], v[68:71], v[32:47]
    ds_read_b32 v2, v108
    ds_read_b64_tr_b16 v[96:97], v113 offset:32256
    ds_read_b64_tr_b16 v[98:99], v113 offset:32400
    ds_read_b128 v[100:103], v111 offset:14336
    s_waitcnt lgkmcnt(10)
    v_mfma_f32_32x32x16_bf16 v[32:47], v[72:75], v[76:79], v[32:47]
    ds_read_b64_tr_b16 v[64:65], v113 offset:34560
    ds_read_b64_tr_b16 v[66:67], v113 offset:34704
    ds_read_b128 v[68:71], v112 offset:14336
    s_waitcnt lgkmcnt(10)
    v_mfma_f32_32x32x16_bf16 v[32:47], v[80:83], v[84:87], v[32:47]
    s_waitcnt lgkmcnt(6)
    v_cmp_gt_i32 vcc, 11, v2
    s_cbranch_vccz f_q4_ok
f_q4:
    ds_read_b32 v2, v108
    s_waitcnt lgkmcnt(0)
    v_cmp_gt_i32 vcc, 11, v2
    s_cbranch_vccnz f_q4
f_q4_ok:
    ds_read_b64_tr_b16 v[72:73], v113 offset:36864
    ds_read_b64_tr_b16 v[74:75], v113 offset:37008
    ds_read_b128 v[76:79], v111 offset:16384
    v_mfma_f32_32x32x16_bf16 v[32:47], v[88:91], v[92:95], v[32:47]
    ds_read_b64_tr_b16 v[80:81], v113 offset:39168
    ds_read_b64_tr_b16 v[82:83], v113 offset:39312
    ds_read_b128 v[84:87], v112 offset:16384
    s_waitcnt lgkmcnt(9)
    v_mfma_f32_32x32x16_bf16 v[32:47], v[96:99], v[100:103], v[32:47]
    ds_read_b32 v2, v108
    ds_read_b64_tr_b16 v[88:89], v113 offset:41472
    ds_read_b64_tr_b16 v[90:91], v113 offset:41616
    ds_read_b128 v[92:95], v111 offset:18432
    s_waitcnt lgkmcnt(10)
    v_mfma_f32_32x32x16_bf16 v[32:47], v[64:67], v[68:71], v[32:47]
    ds_read_b64_tr_b16 v[96:97], v113 offset:43776
    ds_read_b64_tr_b16 v[98:99], v113 offset:43920
    ds_read_b128 v[100:103], v112 offset:18432
    s_waitcnt lgkmcnt(10)
    v_mfma_f32_32x32x16_bf16 v[32:47], v[72:75], v[76:79], v[32:47]
    s_waitcnt lgkmcnt(6)
    v_cmp_gt_i32 vcc, 12, v2
    s_cbranch_vccz f_q5_ok
f_q5:
    ds_read_b32 v2, v108
    s_waitcnt lgkmcnt(0)
    v_cmp_gt_i32 vcc, 12, v2
    s_cbranch_vccnz f_q5
f_q5_ok:
    ds_read_b64_tr_b16 v[64:65], v114 offset:0
    ds_read_b64_tr_b16 v[66:67], v114 offset:144
    ds_read_b128 v[68:71], v111 offset:20480
    v_mfma_f32_32x32x16_bf16 v[32:47], v[80:83], v[84:87], v[32:47]
    ds_read_b64_tr_b16 v[72:73], v114 offset:2304
    ds_read_b64_tr_b16 v[74:75], v114 offset:2448
    ds_read_b128 v[76:79], v112 offset:20480
    s_waitcnt lgkmcnt(9)
    v_mfma_f32_32x32x16_bf16 v[32:47], v[88:91], v[92:95], v[32:47]
    ds_read_b32 v2, v108
    ds_read_b64_tr_b16 v[80:81], v114 offset:4608
    ds_read_b64_tr_b16 v[82:83], v114 offset:4752
    ds_read_b128 v[84:87], v111 offset:22528
    s_waitcnt lgkmcnt(10)
    v_mfma_f32_32x32x16_bf16 v[32:47], v[96:99], v[100:103], v[32:47]
    v_mov_b32 v3, 2
    ds_write_b32 v109, v3
    ds_read_b64_tr_b16 v[88:89], v114 offset:6912
    ds_read_b64_tr_b16 v[90:91], v114 offset:7056
    ds_read_b128 v[92:95], v112 offset:22528
    s_waitcnt lgkmcnt(11)
    v_mfma_f32_32x32x16_bf16 v[32:47], v[64:67], v[68:71], v[32:47]
    s_waitcnt lgkmcnt(7)
    v_cmp_gt_i32 vcc, 13, v2
    s_cbranch_vccz f_q6_ok
f_q6:
    ds_read_b32 v2, v108
    s_waitcnt lgkmcnt(0)
    v_cmp_gt_i32 vcc, 13, v2
    s_cbranch_vccnz f_q6
f_q6_ok:
    ds_read_b64_tr_b16 v[96:97], v114 offset:9216
    ds_read_b64_tr_b16 v[98:99], v114 offset:9360
    ds_read_b128 v[100:103], v111 offset:24576
    v_mfma_f32_32x32x16_bf16 v[32:47], v[72:75], v[76:79], v[32:47]
    s_cmp_lg_u32 s71, 0
    s_cbranch_scc1 f_z0
    v_mov_b32 v136, 0
    v_mov_b32 v137, 0
    v_mov_b32 v138, 0
    v_mov_b32 v139, 0
    v_mov_b32 v140, 0
    v_mov_b32 v141, 0
    v_mov_b32 v142, 0
    v_mov_b32 v143, 0
    v_mov_b32 v144, 0
    v_mov_b32 v145, 0
    v_mov_b32 v146, 0
    v_mov_b32 v147, 0
    v_mov_b32 v148, 0
    v_mov_b32 v149, 0
    v_mov_b32 v150, 0
    v_mov_b32 v151, 0
    v_mov_b32 v152, 0
    v_mov_b32 v153, 0
    v_mov_b32 v154, 0
    v_mov_b32 v155, 0
    v_mov_b32 v156, 0
    v_mov_b32 v157, 0
    v_mov_b32 v158, 0
    v_mov_b32 v159, 0
    v_mov_b32 v160, 0
    v_mov_b32 v161, 0
    v_mov_b32 v162, 0
    v_mov_b32 v163, 0
    v_mov_b32 v164, 0
    v_mov_b32 v165, 0
    v_mov_b32 v166, 0
    v_mov_b32 v167, 0
f_z0:
    ds_read_b64_tr_b16 v[64:65], v114 offset:11520
    ds_read_b64_tr_b16 v[66:67], v114 offset:11664
    ds_read_b128 v[68:71], v112 offset:24576
    s_waitcnt lgkmcnt(10)
    v_mfma_f32_32x32x16_bf16 v[32:47], v[80:83], v[84:87], v[32:47]
    ds_read_b32 v2, v108
    ds_read_b64_tr_b16 v[72:73], v114 offset:13824
    ds_read_b64_tr_b16 v[74:75], v114 offset:13968
    ds_read_b128 v[76:79], v111 offset:26624
    s_waitcnt lgkmcnt(10)
    v_mfma_f32_32x32x16_bf16 v[32:47], v[88:91], v[92:95], v[32:47]
    ds_read_b64_tr_b16 v[80:81], v114 offset:16128
    ds_read_b64_tr_b16 v[82:83], v114 offset:16272
    ds_read_b128 v[84:87], v112 offset:26624
    s_waitcnt lgkmcnt(10)
    v_mfma_f32_32x32x16_bf16 v[32:47], v[96:99], v[100:103], v[32:47]
    s_waitcnt lgkmcnt(6)
    v_cmp_gt_i32 vcc, 14, v2
    s_cbranch_vccz f_q7_ok
f_q7:
    ds_read_b32 v2, v108
    s_waitcnt lgkmcnt(0)
    v_cmp_gt_i32 vcc, 14, v2
    s_cbranch_vccnz f_q7
f_q7_ok:
    ds_read_b64_tr_b16 v[88:89], v114 offset:18432
    ds_read_b64_tr_b16 v[90:91], v114 offset:18576
    ds_read_b128 v[92:95], v111 offset:28672
    v_mfma_f32_32x32x16_bf16 v[32:47], v[64:67], v[68:71], v[32:47]
    ds_read_b64_tr_b16 v[96:97], v114 offset:20736
    ds_read_b64_tr_b16 v[98:99], v114 offset:20880
    ds_read_b128 v[100:103], v112 offset:28672
    s_waitcnt lgkmcnt(9)
    v_mfma_f32_32x32x16_bf16 v[32:47], v[72:75], v[76:79], v[32:47]
    ds_read_b32 v2, v108
    ds_read_b64_tr_b16 v[64:65], v114 offset:23040
    ds_read_b64_tr_b16 v[66:67], v114 offset:23184
    ds_read_b128 v[68:71], v111 offset:30720
    s_waitcnt lgkmcnt(10)
    v_mfma_f32_32x32x16_bf16 v[32:47], v[80:83], v[84:87], v[32:47]
    ds_read_b64_tr_b16 v[72:73], v114 offset:25344
    ds_read_b64_tr_b16 v[74:75], v114 offset:25488
    ds_read_b128 v[76:79], v112 offset:30720
    s_waitcnt lgkmcnt(10)
    v_mfma_f32_32x32x16_bf16 v[32:47], v[88:91], v[92:95], v[32:47]
    s_waitcnt lgkmcnt(6)
    v_cmp_gt_i32 vcc, 15, v2
    s_cbranch_vccz f_q8_ok
f_q8:
    ds_read_b32 v2, v108
    s_waitcnt lgkmcnt(0)
    v_cmp_gt_i32 vcc, 15, v2
    s_cbranch_vccnz f_q8
f_q8_ok:
    ds_read_b64_tr_b16 v[80:81], v114 offset:27648
    ds_read_b64_tr_b16 v[82:83], v114 offset:27792
    ds_read_b128 v[84:87], v111 offset:32768
    v_mfma_f32_32x32x16_bf16 v[32:47], v[96:99], v[100:103], v[32:47]
    ds_read_b64_tr_b16 v[88:89], v114 offset:29952
    ds_read_b64_tr_b16 v[90:91], v114 offset:30096
    ds_read_b128 v[92:95], v112 offset:32768
    s_waitcnt lgkmcnt(9)
    v_mfma_f32_32x32x16_bf16 v[32:47], v[64:67], v[68:71], v[32:47]
    ds_read_b64_tr_b16 v[96:97], v114 offset:32256
    ds_read_b64_tr_b16 v[98:99], v114 offset:32400
    ds_read_b128 v[100:103], v111 offset:34816
    s_waitcnt lgkmcnt(9)
    v_mfma_f32_32x32x16_bf16 v[32:47], v[72:75], v[76:79], v[32:47]
    v_and_b32 v14, 28, v129
    v_add_u32 v14, 159760, v14
    ds_read_b32 v15, v14
    ds_read_b64_tr_b16 v[64:65], v114 offset:34560
    ds_read_b64_tr_b16 v[66:67], v114 offset:34704
    ds_read_b128 v[68:71], v112 offset:34816
    s_waitcnt lgkmcnt(10)
    v_mfma_f32_32x32x16_bf16 v[32:47], v[80:83], v[84:87], v[32:47]
    s_waitcnt lgkmcnt(7)
    v_mfma_f32_32x32x16_bf16 v[32:47], v[88:91], v[92:95], v[32:47]
    s_waitcnt lgkmcnt(4)
    v_mfma_f32_32x32x16_bf16 v[32:47], v[96:99], v[100:103], v[32:47]
    s_waitcnt lgkmcnt(0)
    v_mfma_f32_32x32x16_bf16 v[32:47], v[64:67], v[68:71], v[32:47]
    s_mov_b32 s60, 1051597459
    s_lshl_b32 s3, s70, 2
    s_add_u32 s3, s3, 159904
    v_mov_b32 v2, s3
    v_xor_b32 v108, 16, v2
    v_mov_b32 v3, 1
    v_cmp_gt_i32 vcc, 2, v15
    s_cbranch_vccz f_q9_ok
f_q9:
    ds_read_b32 v15, v14
    s_waitcnt lgkmcnt(0)
    v_cmp_gt_i32 vcc, 2, v15
    s_cbranch_vccnz f_q9
f_q9_ok:
    s_nop 1
    s_bitcmp1_b32 s72, 0
    s_cbranch_scc1 f_qodd
    v_mul_f32 v48, s60, v32
    v_mul_f32 v49, s60, v33
    v_mul_f32 v50, s60, v34
    v_mul_f32 v51, s60, v35
    v_mul_f32 v52, s60, v36
    v_mul_f32 v53, s60, v37
    v_mul_f32 v54, s60, v38
    v_mul_f32 v55, s60, v39
    v_mul_f32 v56, s60, v40
    v_mul_f32 v57, s60, v41
    s_branch f_qdone
f_qodd:
    v_mul_f32 v48, s60, v34
    v_mul_f32 v49, s60, v35
    v_mul_f32 v50, s60, v36
    v_mul_f32 v51, s60, v37
    v_mul_f32 v52, s60, v38
    v_mul_f32 v53, s60, v39
    v_mul_f32 v54, s60, v40
    v_mul_f32 v55, s60, v41
    v_mul_f32 v56, s60, v46
    v_mul_f32 v57, s60, v47
f_qdone:
    v_cvt_pk_bf16_f32 v4, v48, v49
    v_cvt_pk_bf16_f32 v5, v50, v51
    v_cvt_pk_bf16_f32 v6, v52, v53
    v_cvt_pk_bf16_f32 v7, v54, v55
    v_cvt_pk_bf16_f32 v8, v56, v57
    v_mov_b32 v9, 0
    ds_write_b128 v131, v[4:7]
    v_cndmask_b32 v8, v8, 0, s[68:69]
    s_mov_b32 exec_hi, 0
    ds_write_b64 v131, v[8:9] offset:1024
    s_mov_b32 exec_hi, -1
    ds_write_b32 v2, v3
    s_mul_i32 s3, s71, -3072
    s_add_u32 s3, s3, 1536
    v_add_u32 v131, s3, v131
    v_mov_b32 v110, 0
    v_mov_b32 v111, 0
f_b1:
    ds_read_b32 v15, v108
    s_waitcnt lgkmcnt(0)
    v_cmp_gt_i32 vcc, 1, v15
    s_cbranch_vccnz f_b1
    ds_read_b128 v[112:115], v131
    s_mov_b32 exec_hi, 0
    ds_read_b64 v[110:111], v131 offset:1024
    s_mov_b32 exec_hi, -1
    v_mov_b32 v3, 3
    s_mul_i32 s3, s72, 6144
    s_add_u32 s3, s3, 56320
    v_lshlrev_b32 v131, 4, v1
    v_add_u32 v131, s3, v131
    s_waitcnt lgkmcnt(0)
    ds_write_b32 v109, v3
    s_cmp_eq_u32 s71, 0
    s_cbranch_scc1 f_go
    s_setprio 3
    v_mov_b32 v136, 0
    v_mov_b32 v137, 0
    v_mov_b32 v138, 0
    v_mov_b32 v139, 0
    v_mov_b32 v140, 0
    v_mov_b32 v141, 0
    v_mov_b32 v142, 0
    v_mov_b32 v143, 0
    v_mov_b32 v144, 0
    v_mov_b32 v145, 0
    v_mov_b32 v146, 0
    v_mov_b32 v147, 0
    v_mov_b32 v148, 0
    v_mov_b32 v149, 0
    v_mov_b32 v150, 0
    v_mov_b32 v151, 0
    v_mov_b32 v152, 0
    v_mov_b32 v153, 0
    v_mov_b32 v154, 0
    v_mov_b32 v155, 0
    v_mov_b32 v156, 0
    v_mov_b32 v157, 0
    v_mov_b32 v158, 0
    v_mov_b32 v159, 0
    v_mov_b32 v160, 0
    v_mov_b32 v161, 0
    v_mov_b32 v162, 0
    v_mov_b32 v163, 0
    v_mov_b32 v164, 0
    v_mov_b32 v165, 0
    v_mov_b32 v166, 0
    v_mov_b32 v167, 0
    v_lshrrev_b32 v15, 5, v1
    s_lshl_b32 s3, s72, 1
    v_add_u32 v32, s3, v15
    v_xor_b32 v32, v32, v1
    v_and_b32 v32, 7, v32
    v_lshlrev_b32 v32, 4, v32
    v_lshl_add_u32 v32, v129, 5, v32
    v_add_u32 v32, 81920, v32
    v_xor_b32 v33, 112, v32
    v_add_u32 v34, 160256, v129
    s_lshl_b32 s3, s72, 2
    s_add_u32 s6, s3, 159856
    v_mov_b32 v35, s6
    s_branch f_b2
f_b2_z:
    s_sleep 1
f_b2:
    ds_read_b32 v15, v14
    s_waitcnt lgkmcnt(0)
    v_cmp_gt_i32 vcc, 3, v15
    s_cbranch_vccnz f_b2_z
    ds_write_b128 v32, v[116:119] offset:0
    ds_write_b128 v32, v[120:123] offset:4096
    ds_write_b128 v33, v[124:127] offset:8192
    ds_write_b128 v33, v[132:135] offset:12288
    s_cmp_lg_u32 s72, 0
    s_cbranch_scc1 f_b3
    s_mov_b32 exec_hi, 0
    ds_write_b32 v34, v130
    s_mov_b32 exec_hi, -1
f_b3:
    v_mov_b32 v3, 1
    ds_write_b32 v35, v3
f_go:
    v_and_b32 v108, 12, v129
    v_add_u32 v108, 159744, v108
    s_lshl_b32 s3, s72, 8
    s_add_u32 s3, s3, 160768
    v_add_u32 v14, s3, v129
    v_mov_b32 v105, 0xbf80
    v_mov_b32 v107, 0xbf80
f_a6:
    ds_read_b32 v15, v108
    s_waitcnt lgkmcnt(0)
    v_cmp_gt_i32 vcc, 1, v15
    s_cbranch_vccnz f_a6
    s_setprio 2
    ds_read_b128 v[96:99], v11 offset:0
    ds_read_b32 v104, v12 offset:0
    s_lshl_b32 s3, s72, 2
    s_add_u32 s3, s3, 159888
    v_mov_b32 v2, s3
    s_cmp_lg_u32 s71, 0
    s_cbranch_scc1 f_m0
    s_waitcnt lgkmcnt(0)
    v_mfma_f32_32x32x16_bf16 v[32:47], v[96:99], v[4:7], 0
    v_mfma_f32_32x32x8_bf16 v[32:47], v[104:105], v[8:9], v[32:47]
    v_mfma_f32_32x32x16_bf16 v[48:63], v[96:99], v[112:115], 0
    v_mfma_f32_32x32x8_bf16 v[48:63], v[104:105], v[110:111], v[48:63]
    v_mov_b32 v3, 1
    s_nop 8
    v_max3_f32 v64, v32, v33, v34
    v_max3_f32 v64, v35, v36, v64
    v_max3_f32 v64, v37, v38, v64
    v_max3_f32 v64, v39, v40, v64
    v_max3_f32 v64, v41, v42, v64
    v_max3_f32 v64, v43, v44, v64
    v_max3_f32 v64, v45, v46, v64
    v_max_f32 v64, v47, v64
    v_mov_b32 v65, v64
    v_max3_f32 v66, v48, v49, v50
    v_max3_f32 v66, v51, v52, v66
    v_max3_f32 v66, v53, v54, v66
    v_max3_f32 v66, v55, v56, v66
    v_max3_f32 v66, v57, v58, v66
    v_max3_f32 v66, v59, v60, v66
    v_max3_f32 v66, v61, v62, v66
    v_max_f32 v66, v63, v66
    v_mov_b32 v67, v66
    s_nop 0
    v_permlane32_swap_b32 v64, v65
    v_max_f32 v64, v64, v65
    v_add_f32 v64, 1120403456, v64
    v_cvt_pk_bf16_f32 v64, v64, 0
    v_cndmask_b32 v9, v64, 0, s[68:69]
    ds_write_b32 v14, v64 offset:0
    v_permlane32_swap_b32 v66, v67
    v_max_f32 v66, v66, v67
    v_add_f32 v66, 1120403456, v66
    v_cvt_pk_bf16_f32 v66, v66, 0
    v_cndmask_b32 v111, v66, 0, s[68:69]
    ds_write_b32 v14, v66 offset:128
    ds_write_b32 v2, v3
    s_branch f_m1
f_m0:
f_m2w:
    ds_read_b32 v15, v2
    s_waitcnt lgkmcnt(0)
    v_cmp_gt_i32 vcc, 1, v15
    s_cbranch_vccnz f_m2w
    s_mov_b32 exec_hi, 0
    ds_read_b32 v9, v14 offset:128
    ds_read_b32 v111, v14 offset:0
    s_mov_b32 exec_hi, -1
    s_waitcnt lgkmcnt(0)
f_m1:
    v_mov_b32 v3, 0xdddd
    v_mfma_f32_32x32x16_bf16 v[32:47], v[96:99], v[4:7], 0
    v_mfma_f32_32x32x8_bf16 v[32:47], v[104:105], v[8:9], v[32:47]
    s_nop 8
f_s0:
    v_mfma_f32_32x32x16_bf16 v[48:63], v[96:99], v[112:115], 0
    ds_read_b128 v[100:103], v11 offset:4864
    ds_read_b32 v106, v12 offset:4864
    v_exp_f32 v32, v32
    v_exp_f32 v33, v33
    v_exp_f32 v34, v34
    v_exp_f32 v35, v35
    v_mfma_f32_32x32x8_bf16 v[48:63], v[104:105], v[110:111], v[48:63]
    ds_read_b128 v[116:119], v13 offset:0
    ds_read_b128 v[120:123], v13 offset:640
    v_exp_f32 v36, v36
    v_exp_f32 v37, v37
    v_exp_f32 v38, v38
    v_exp_f32 v39, v39
    v_exp_f32 v40, v40
    v_exp_f32 v41, v41
    v_exp_f32 v42, v42
    v_exp_f32 v43, v43
    v_exp_f32 v44, v44
    v_exp_f32 v45, v45
    v_exp_f32 v46, v46
    v_exp_f32_e64 v47, v47
    s_waitcnt lgkmcnt(0)
f_s1:
    v_mfma_f32_32x32x16_bf16 v[64:79], v[100:103], v[4:7], 0
    v_exp_f32 v48, v48
    v_exp_f32 v49, v49
    v_exp_f32 v50, v50
    v_exp_f32 v51, v51
    v_mfma_f32_32x32x8_bf16 v[64:79], v[106:107], v[8:9], v[64:79]
    v_exp_f32 v52, v52
    v_exp_f32 v53, v53
    v_exp_f32 v54, v54
    v_exp_f32 v55, v55
    v_smfmac_f32_32x32x32_bf16 v[136:151], v[116:119], v[32:39], v3
    v_exp_f32 v56, v56
    v_exp_f32 v57, v57
    v_exp_f32 v58, v58
    v_exp_f32 v59, v59
    v_smfmac_f32_32x32x32_bf16 v[136:151], v[120:123], v[40:47], v3
    v_exp_f32 v60, v60
    v_exp_f32 v61, v61
    v_exp_f32 v62, v62
    v_exp_f32 v63, v63
f_s2:
    v_mfma_f32_32x32x16_bf16 v[32:47], v[100:103], v[112:115], 0
    ds_read_b128 v[96:99], v11 offset:9728
    ds_read_b32 v104, v12 offset:9728
    v_exp_f32 v64, v64
    v_exp_f32 v65, v65
    v_exp_f32 v66, v66
    v_exp_f32 v67, v67
    v_mfma_f32_32x32x8_bf16 v[32:47], v[106:107], v[110:111], v[32:47]
    ds_read_b128 v[80:83], v13 offset:4864
    ds_read_b128 v[84:87], v13 offset:5504
    v_exp_f32 v68, v68
    v_exp_f32 v69, v69
    v_exp_f32 v70, v70
    v_exp_f32 v71, v71
    v_smfmac_f32_32x32x32_bf16 v[152:167], v[116:119], v[48:55], v3
    v_exp_f32 v72, v72
    v_exp_f32 v73, v73
    v_exp_f32 v74, v74
    v_exp_f32 v75, v75
    v_smfmac_f32_32x32x32_bf16 v[152:167], v[120:123], v[56:63], v3
    v_exp_f32 v76, v76
    v_exp_f32 v77, v77
    v_exp_f32 v78, v78
    v_exp_f32_e64 v79, v79
    s_waitcnt lgkmcnt(0)
f_s3:
    v_mfma_f32_32x32x16_bf16 v[48:63], v[96:99], v[4:7], 0
    v_exp_f32 v32, v32
    v_exp_f32 v33, v33
    v_exp_f32 v34, v34
    v_exp_f32 v35, v35
    v_mfma_f32_32x32x8_bf16 v[48:63], v[104:105], v[8:9], v[48:63]
    v_exp_f32 v36, v36
    v_exp_f32 v37, v37
    v_exp_f32 v38, v38
    v_exp_f32 v39, v39
    v_smfmac_f32_32x32x32_bf16 v[136:151], v[80:83], v[64:71], v3
    v_exp_f32 v40, v40
    v_exp_f32 v41, v41
    v_exp_f32 v42, v42
    v_exp_f32 v43, v43
    v_smfmac_f32_32x32x32_bf16 v[136:151], v[84:87], v[72:79], v3
    v_exp_f32 v44, v44
    v_exp_f32 v45, v45
    v_exp_f32 v46, v46
    v_exp_f32_e64 v47, v47
f_w2:
    ds_read_b32 v2, v108
    s_waitcnt lgkmcnt(0)
    v_cmp_gt_i32 vcc, 2, v2
    s_cbranch_vccnz f_w2
f_s4:
    v_mfma_f32_32x32x16_bf16 v[64:79], v[96:99], v[112:115], 0
    ds_read_b128 v[100:103], v11 offset:14592
    ds_read_b32 v106, v12 offset:14592
    v_exp_f32 v48, v48
    v_exp_f32 v49, v49
    v_exp_f32 v50, v50
    v_exp_f32 v51, v51
    v_mfma_f32_32x32x8_bf16 v[64:79], v[104:105], v[110:111], v[64:79]
    ds_read_b128 v[116:119], v13 offset:9728
    ds_read_b128 v[120:123], v13 offset:10368
    v_exp_f32 v52, v52
    v_exp_f32 v53, v53
    v_exp_f32 v54, v54
    v_exp_f32 v55, v55
    v_smfmac_f32_32x32x32_bf16 v[152:167], v[80:83], v[32:39], v3
    v_exp_f32 v56, v56
    v_exp_f32 v57, v57
    v_exp_f32 v58, v58
    v_exp_f32 v59, v59
    v_smfmac_f32_32x32x32_bf16 v[152:167], v[84:87], v[40:47], v3
    v_exp_f32 v60, v60
    v_exp_f32 v61, v61
    v_exp_f32 v62, v62
    v_exp_f32_e64 v63, v63
    s_waitcnt lgkmcnt(0)
f_s5:
    v_mfma_f32_32x32x16_bf16 v[32:47], v[100:103], v[4:7], 0
    v_exp_f32 v64, v64
    v_exp_f32 v65, v65
    v_exp_f32 v66, v66
    v_exp_f32 v67, v67
    v_mfma_f32_32x32x8_bf16 v[32:47], v[106:107], v[8:9], v[32:47]
    v_exp_f32 v68, v68
    v_exp_f32 v69, v69
    v_exp_f32 v70, v70
    v_exp_f32 v71, v71
    v_smfmac_f32_32x32x32_bf16 v[136:151], v[116:119], v[48:55], v3
    v_exp_f32 v72, v72
    v_exp_f32 v73, v73
    v_exp_f32 v74, v74
    v_exp_f32 v75, v75
    v_smfmac_f32_32x32x32_bf16 v[136:151], v[120:123], v[56:63], v3
    v_exp_f32 v76, v76
    v_exp_f32 v77, v77
    v_exp_f32 v78, v78
    v_exp_f32 v79, v79
f_s6:
    v_mfma_f32_32x32x16_bf16 v[48:63], v[100:103], v[112:115], 0
    ds_read_b128 v[96:99], v11 offset:19456
    ds_read_b32 v104, v12 offset:19456
    v_exp_f32 v32, v32
    v_exp_f32 v33, v33
    v_exp_f32 v34, v34
    v_exp_f32 v35, v35
    v_mfma_f32_32x32x8_bf16 v[48:63], v[106:107], v[110:111], v[48:63]
    ds_read_b128 v[80:83], v13 offset:14592
    ds_read_b128 v[84:87], v13 offset:15232
    v_exp_f32 v36, v36
    v_exp_f32 v37, v37
    v_exp_f32 v38, v38
    v_exp_f32 v39, v39
    v_smfmac_f32_32x32x32_bf16 v[152:167], v[116:119], v[64:71], v3
    v_exp_f32 v40, v40
    v_exp_f32 v41, v41
    v_exp_f32 v42, v42
    v_exp_f32 v43, v43
    v_smfmac_f32_32x32x32_bf16 v[152:167], v[120:123], v[72:79], v3
    v_exp_f32 v44, v44
    v_exp_f32 v45, v45
    v_exp_f32 v46, v46
    v_exp_f32_e64 v47, v47
    s_waitcnt lgkmcnt(0)
f_s7:
    v_mfma_f32_32x32x16_bf16 v[64:79], v[96:99], v[4:7], 0
    v_exp_f32 v48, v48
    v_exp_f32 v49, v49
    v_exp_f32 v50, v50
    v_exp_f32 v51, v51
    v_mfma_f32_32x32x8_bf16 v[64:79], v[104:105], v[8:9], v[64:79]
    v_exp_f32 v52, v52
    v_exp_f32 v53, v53
    v_exp_f32 v54, v54
    v_exp_f32 v55, v55
    v_smfmac_f32_32x32x32_bf16 v[136:151], v[80:83], v[32:39], v3
    v_exp_f32 v56, v56
    v_exp_f32 v57, v57
    v_exp_f32 v58, v58
    v_exp_f32 v59, v59
    v_smfmac_f32_32x32x32_bf16 v[136:151], v[84:87], v[40:47], v3
    v_exp_f32 v60, v60
    v_exp_f32 v61, v61
    v_exp_f32 v62, v62
    v_exp_f32 v63, v63
f_s8:
    v_mfma_f32_32x32x16_bf16 v[32:47], v[96:99], v[112:115], 0
    ds_read_b128 v[100:103], v11 offset:24320
    ds_read_b32 v106, v12 offset:24320
    v_exp_f32 v64, v64
    v_exp_f32 v65, v65
    v_exp_f32 v66, v66
    v_exp_f32 v67, v67
    v_mfma_f32_32x32x8_bf16 v[32:47], v[104:105], v[110:111], v[32:47]
    ds_read_b128 v[116:119], v13 offset:19456
    ds_read_b128 v[120:123], v13 offset:20096
    v_exp_f32 v68, v68
    v_exp_f32 v69, v69
    v_exp_f32 v70, v70
    v_exp_f32 v71, v71
    v_smfmac_f32_32x32x32_bf16 v[152:167], v[80:83], v[48:55], v3
    v_exp_f32 v72, v72
    v_exp_f32 v73, v73
    v_exp_f32 v74, v74
    v_exp_f32 v75, v75
    v_smfmac_f32_32x32x32_bf16 v[152:167], v[84:87], v[56:63], v3
    v_exp_f32 v76, v76
    v_exp_f32 v77, v77
    v_exp_f32 v78, v78
    v_exp_f32_e64 v79, v79
    s_waitcnt lgkmcnt(0)
f_s9:
    v_mfma_f32_32x32x16_bf16 v[48:63], v[100:103], v[4:7], 0
    v_exp_f32 v32, v32
    v_exp_f32 v33, v33
    v_exp_f32 v34, v34
    v_exp_f32 v35, v35
    v_mfma_f32_32x32x8_bf16 v[48:63], v[106:107], v[8:9], v[48:63]
    v_exp_f32 v36, v36
    v_exp_f32 v37, v37
    v_exp_f32 v38, v38
    v_exp_f32 v39, v39
    v_smfmac_f32_32x32x32_bf16 v[136:151], v[116:119], v[64:71], v3
    v_exp_f32 v40, v40
    v_exp_f32 v41, v41
    v_exp_f32 v42, v42
    v_exp_f32 v43, v43
    v_smfmac_f32_32x32x32_bf16 v[136:151], v[120:123], v[72:79], v3
    v_exp_f32 v44, v44
    v_exp_f32 v45, v45
    v_exp_f32 v46, v46
    v_exp_f32_e64 v47, v47
f_w5:
    ds_read_b32 v2, v108
    s_waitcnt lgkmcnt(0)
    v_cmp_gt_i32 vcc, 3, v2
    s_cbranch_vccnz f_w5
f_s10:
    v_mfma_f32_32x32x16_bf16 v[64:79], v[100:103], v[112:115], 0
    ds_read_b128 v[96:99], v11 offset:29184
    ds_read_b32 v104, v12 offset:29184
    v_exp_f32 v48, v48
    v_exp_f32 v49, v49
    v_exp_f32 v50, v50
    v_exp_f32 v51, v51
    v_mfma_f32_32x32x8_bf16 v[64:79], v[106:107], v[110:111], v[64:79]
    ds_read_b128 v[80:83], v13 offset:24320
    ds_read_b128 v[84:87], v13 offset:24960
    v_exp_f32 v52, v52
    v_exp_f32 v53, v53
    v_exp_f32 v54, v54
    v_exp_f32 v55, v55
    v_smfmac_f32_32x32x32_bf16 v[152:167], v[116:119], v[32:39], v3
    v_exp_f32 v56, v56
    v_exp_f32 v57, v57
    v_exp_f32 v58, v58
    v_exp_f32 v59, v59
    v_smfmac_f32_32x32x32_bf16 v[152:167], v[120:123], v[40:47], v3
    v_exp_f32 v60, v60
    v_exp_f32 v61, v61
    v_exp_f32 v62, v62
    v_exp_f32_e64 v63, v63
    s_waitcnt lgkmcnt(0)
f_s11:
    v_mfma_f32_32x32x16_bf16 v[32:47], v[96:99], v[4:7], 0
    v_exp_f32 v64, v64
    v_exp_f32 v65, v65
    v_exp_f32 v66, v66
    v_exp_f32 v67, v67
    v_mfma_f32_32x32x8_bf16 v[32:47], v[104:105], v[8:9], v[32:47]
    v_exp_f32 v68, v68
    v_exp_f32 v69, v69
    v_exp_f32 v70, v70
    v_exp_f32 v71, v71
    v_smfmac_f32_32x32x32_bf16 v[136:151], v[80:83], v[48:55], v3
    v_exp_f32 v72, v72
    v_exp_f32 v73, v73
    v_exp_f32 v74, v74
    v_exp_f32 v75, v75
    v_smfmac_f32_32x32x32_bf16 v[136:151], v[84:87], v[56:63], v3
    v_exp_f32 v76, v76
    v_exp_f32 v77, v77
    v_exp_f32 v78, v78
    v_exp_f32 v79, v79
f_s12:
    v_mfma_f32_32x32x16_bf16 v[48:63], v[96:99], v[112:115], 0
    ds_read_b128 v[100:103], v11 offset:34048
    ds_read_b32 v106, v12 offset:34048
    v_exp_f32 v32, v32
    v_exp_f32 v33, v33
    v_exp_f32 v34, v34
    v_exp_f32 v35, v35
    v_mfma_f32_32x32x8_bf16 v[48:63], v[104:105], v[110:111], v[48:63]
    ds_read_b128 v[116:119], v13 offset:29184
    ds_read_b128 v[120:123], v13 offset:29824
    v_exp_f32 v36, v36
    v_exp_f32 v37, v37
    v_exp_f32 v38, v38
    v_exp_f32 v39, v39
    v_smfmac_f32_32x32x32_bf16 v[152:167], v[80:83], v[64:71], v3
    v_exp_f32 v40, v40
    v_exp_f32 v41, v41
    v_exp_f32 v42, v42
    v_exp_f32 v43, v43
    v_smfmac_f32_32x32x32_bf16 v[152:167], v[84:87], v[72:79], v3
    v_exp_f32 v44, v44
    v_exp_f32 v45, v45
    v_exp_f32 v46, v46
    v_exp_f32_e64 v47, v47
    s_waitcnt lgkmcnt(0)
f_s13:
    v_mfma_f32_32x32x16_bf16 v[64:79], v[100:103], v[4:7], 0
    v_exp_f32 v48, v48
    v_exp_f32 v49, v49
    v_exp_f32 v50, v50
    v_exp_f32 v51, v51
    v_mfma_f32_32x32x8_bf16 v[64:79], v[106:107], v[8:9], v[64:79]
    v_exp_f32 v52, v52
    v_exp_f32 v53, v53
    v_exp_f32 v54, v54
    v_exp_f32 v55, v55
    v_smfmac_f32_32x32x32_bf16 v[136:151], v[116:119], v[32:39], v3
    v_exp_f32 v56, v56
    v_exp_f32 v57, v57
    v_exp_f32 v58, v58
    v_exp_f32 v59, v59
    v_smfmac_f32_32x32x32_bf16 v[136:151], v[120:123], v[40:47], v3
    v_exp_f32 v60, v60
    v_exp_f32 v61, v61
    v_exp_f32 v62, v62
    v_exp_f32 v63, v63
f_s14:
    v_mfma_f32_32x32x16_bf16 v[32:47], v[100:103], v[112:115], 0
    ds_read_b128 v[96:99], v11 offset:38912
    ds_read_b32 v104, v12 offset:38912
    v_exp_f32 v64, v64
    v_exp_f32 v65, v65
    v_exp_f32 v66, v66
    v_exp_f32 v67, v67
    v_mfma_f32_32x32x8_bf16 v[32:47], v[106:107], v[110:111], v[32:47]
    ds_read_b128 v[80:83], v13 offset:34048
    ds_read_b128 v[84:87], v13 offset:34688
    v_exp_f32 v68, v68
    v_exp_f32 v69, v69
    v_exp_f32 v70, v70
    v_exp_f32 v71, v71
    v_smfmac_f32_32x32x32_bf16 v[152:167], v[116:119], v[48:55], v3
    v_exp_f32 v72, v72
    v_exp_f32 v73, v73
    v_exp_f32 v74, v74
    v_exp_f32 v75, v75
    v_smfmac_f32_32x32x32_bf16 v[152:167], v[120:123], v[56:63], v3
    v_exp_f32 v76, v76
    v_exp_f32 v77, v77
    v_exp_f32 v78, v78
    v_exp_f32_e64 v79, v79
    s_waitcnt lgkmcnt(0)
f_s15:
    v_mfma_f32_32x32x16_bf16 v[48:63], v[96:99], v[4:7], 0
    v_exp_f32 v32, v32
    v_exp_f32 v33, v33
    v_exp_f32 v34, v34
    v_exp_f32 v35, v35
    v_mfma_f32_32x32x8_bf16 v[48:63], v[104:105], v[8:9], v[48:63]
    v_exp_f32 v36, v36
    v_exp_f32 v37, v37
    v_exp_f32 v38, v38
    v_exp_f32 v39, v39
    v_smfmac_f32_32x32x32_bf16 v[136:151], v[80:83], v[64:71], v3
    v_exp_f32 v40, v40
    v_exp_f32 v41, v41
    v_exp_f32 v42, v42
    v_exp_f32 v43, v43
    v_smfmac_f32_32x32x32_bf16 v[136:151], v[84:87], v[72:79], v3
    v_exp_f32 v44, v44
    v_exp_f32 v45, v45
    v_exp_f32 v46, v46
    v_exp_f32 v47, v47
f_s16:
    v_mfma_f32_32x32x16_bf16 v[64:79], v[96:99], v[112:115], 0
    ds_read_b128 v[100:103], v11 offset:43776
    ds_read_b32 v106, v12 offset:43776
    v_exp_f32 v48, v48
    v_exp_f32 v49, v49
    v_exp_f32 v50, v50
    v_exp_f32 v51, v51
    v_mfma_f32_32x32x8_bf16 v[64:79], v[104:105], v[110:111], v[64:79]
    ds_read_b128 v[116:119], v13 offset:38912
    ds_read_b128 v[120:123], v13 offset:39552
    v_exp_f32 v52, v52
    v_exp_f32 v53, v53
    v_exp_f32 v54, v54
    v_exp_f32 v55, v55
    v_smfmac_f32_32x32x32_bf16 v[152:167], v[80:83], v[32:39], v3
    v_exp_f32 v56, v56
    v_exp_f32 v57, v57
    v_exp_f32 v58, v58
    v_exp_f32 v59, v59
    v_smfmac_f32_32x32x32_bf16 v[152:167], v[84:87], v[40:47], v3
    v_exp_f32 v60, v60
    v_exp_f32 v61, v61
    v_exp_f32 v62, v62
    v_exp_f32_e64 v63, v63
    s_waitcnt lgkmcnt(0)
f_s17:
    v_mfma_f32_32x32x16_bf16 v[32:47], v[100:103], v[4:7], 0
    v_exp_f32 v64, v64
    v_exp_f32 v65, v65
    v_exp_f32 v66, v66
    v_exp_f32 v67, v67
    v_mfma_f32_32x32x8_bf16 v[32:47], v[106:107], v[8:9], v[32:47]
    v_exp_f32 v68, v68
    v_exp_f32 v69, v69
    v_exp_f32 v70, v70
    v_exp_f32 v71, v71
    v_smfmac_f32_32x32x32_bf16 v[136:151], v[116:119], v[48:55], v3
    v_exp_f32 v72, v72
    v_exp_f32 v73, v73
    v_exp_f32 v74, v74
    v_exp_f32 v75, v75
    v_smfmac_f32_32x32x32_bf16 v[136:151], v[120:123], v[56:63], v3
    v_exp_f32 v76, v76
    v_exp_f32 v77, v77
    v_exp_f32 v78, v78
    v_exp_f32 v79, v79
    v_add_u32 v11, 4294856704, v11
    v_add_u32 v12, 4294856704, v12
f_s18:
    v_mfma_f32_32x32x16_bf16 v[48:63], v[100:103], v[112:115], 0
    ds_read_b128 v[96:99], v11 offset:0
    ds_read_b32 v104, v12 offset:0
    v_exp_f32 v32, v32
    v_exp_f32 v33, v33
    v_exp_f32 v34, v34
    v_exp_f32 v35, v35
    v_mfma_f32_32x32x8_bf16 v[48:63], v[106:107], v[110:111], v[48:63]
    ds_read_b128 v[80:83], v13 offset:43776
    ds_read_b128 v[84:87], v13 offset:44416
    v_exp_f32 v36, v36
    v_exp_f32 v37, v37
    v_exp_f32 v38, v38
    v_exp_f32 v39, v39
    v_smfmac_f32_32x32x32_bf16 v[152:167], v[116:119], v[64:71], v3
    v_exp_f32 v40, v40
    v_exp_f32 v41, v41
    v_exp_f32 v42, v42
    v_exp_f32 v43, v43
    v_smfmac_f32_32x32x32_bf16 v[152:167], v[120:123], v[72:79], v3
    v_exp_f32 v44, v44
    v_exp_f32 v45, v45
    v_exp_f32 v46, v46
    v_exp_f32_e64 v47, v47
    s_waitcnt lgkmcnt(0)
f_s19:
    v_mfma_f32_32x32x16_bf16 v[64:79], v[96:99], v[4:7], 0
    v_exp_f32 v48, v48
    v_exp_f32 v49, v49
    v_exp_f32 v50, v50
    v_exp_f32 v51, v51
    v_mfma_f32_32x32x8_bf16 v[64:79], v[104:105], v[8:9], v[64:79]
    v_exp_f32 v52, v52
    v_exp_f32 v53, v53
    v_exp_f32 v54, v54
    v_exp_f32 v55, v55
    v_smfmac_f32_32x32x32_bf16 v[136:151], v[80:83], v[32:39], v3
    v_exp_f32 v56, v56
    v_exp_f32 v57, v57
    v_exp_f32 v58, v58
    v_exp_f32 v59, v59
    v_smfmac_f32_32x32x32_bf16 v[136:151], v[84:87], v[40:47], v3
    v_exp_f32 v60, v60
    v_exp_f32 v61, v61
    v_exp_f32 v62, v62
    v_exp_f32_e64 v63, v63
    v_mov_b32 v15, 4
    ds_write_b32 v109, v15
    v_add_u32 v13, 4294856704, v13
f_s20:
    v_mfma_f32_32x32x16_bf16 v[32:47], v[96:99], v[112:115], 0
    ds_read_b128 v[100:103], v11 offset:4864
    ds_read_b32 v106, v12 offset:4864
    v_exp_f32 v64, v64
    v_exp_f32 v65, v65
    v_exp_f32 v66, v66
    v_exp_f32 v67, v67
    v_mfma_f32_32x32x8_bf16 v[32:47], v[104:105], v[110:111], v[32:47]
    ds_read_b128 v[116:119], v13 offset:0
    ds_read_b128 v[120:123], v13 offset:640
    v_exp_f32 v68, v68
    v_exp_f32 v69, v69
    v_exp_f32 v70, v70
    v_exp_f32 v71, v71
    v_smfmac_f32_32x32x32_bf16 v[152:167], v[80:83], v[48:55], v3
    v_exp_f32 v72, v72
    v_exp_f32 v73, v73
    v_exp_f32 v74, v74
    v_exp_f32 v75, v75
    v_smfmac_f32_32x32x32_bf16 v[152:167], v[84:87], v[56:63], v3
    v_exp_f32 v76, v76
    v_exp_f32 v77, v77
    v_exp_f32 v78, v78
    v_exp_f32_e64 v79, v79
    s_waitcnt lgkmcnt(0)
f_s21:
    v_mfma_f32_32x32x16_bf16 v[48:63], v[100:103], v[4:7], 0
    v_exp_f32 v32, v32
    v_exp_f32 v33, v33
    v_exp_f32 v34, v34
    v_exp_f32 v35, v35
    v_mfma_f32_32x32x8_bf16 v[48:63], v[106:107], v[8:9], v[48:63]
    v_exp_f32 v36, v36
    v_exp_f32 v37, v37
    v_exp_f32 v38, v38
    v_exp_f32 v39, v39
    v_smfmac_f32_32x32x32_bf16 v[136:151], v[116:119], v[64:71], v3
    v_exp_f32 v40, v40
    v_exp_f32 v41, v41
    v_exp_f32 v42, v42
    v_exp_f32 v43, v43
    v_smfmac_f32_32x32x32_bf16 v[136:151], v[120:123], v[72:79], v3
    v_exp_f32 v44, v44
    v_exp_f32 v45, v45
    v_exp_f32 v46, v46
    v_exp_f32 v47, v47
f_s22:
    v_mfma_f32_32x32x16_bf16 v[64:79], v[100:103], v[112:115], 0
    ds_read_b128 v[96:99], v11 offset:9728
    ds_read_b32 v104, v12 offset:9728
    v_exp_f32 v48, v48
    v_exp_f32 v49, v49
    v_exp_f32 v50, v50
    v_exp_f32 v51, v51
    v_mfma_f32_32x32x8_bf16 v[64:79], v[106:107], v[110:111], v[64:79]
    ds_read_b128 v[80:83], v13 offset:4864
    ds_read_b128 v[84:87], v13 offset:5504
    v_exp_f32 v52, v52
    v_exp_f32 v53, v53
    v_exp_f32 v54, v54
    v_exp_f32 v55, v55
    v_smfmac_f32_32x32x32_bf16 v[152:167], v[116:119], v[32:39], v3
    v_exp_f32 v56, v56
    v_exp_f32 v57, v57
    v_exp_f32 v58, v58
    v_exp_f32 v59, v59
    v_smfmac_f32_32x32x32_bf16 v[152:167], v[120:123], v[40:47], v3
    v_exp_f32 v60, v60
    v_exp_f32 v61, v61
    v_exp_f32 v62, v62
    v_exp_f32_e64 v63, v63
    s_waitcnt lgkmcnt(0)
f_s23:
    v_mfma_f32_32x32x16_bf16 v[32:47], v[96:99], v[4:7], 0
    v_exp_f32 v64, v64
    v_exp_f32 v65, v65
    v_exp_f32 v66, v66
    v_exp_f32 v67, v67
    v_mfma_f32_32x32x8_bf16 v[32:47], v[104:105], v[8:9], v[32:47]
    v_exp_f32 v68, v68
    v_exp_f32 v69, v69
    v_exp_f32 v70, v70
    v_exp_f32 v71, v71
    v_smfmac_f32_32x32x32_bf16 v[136:151], v[80:83], v[48:55], v3
    v_exp_f32 v72, v72
    v_exp_f32 v73, v73
    v_exp_f32 v74, v74
    v_exp_f32 v75, v75
    v_smfmac_f32_32x32x32_bf16 v[136:151], v[84:87], v[56:63], v3
    v_exp_f32 v76, v76
    v_exp_f32 v77, v77
    v_exp_f32 v78, v78
    v_exp_f32_e64 v79, v79
f_w12:
    ds_read_b32 v2, v108
    s_waitcnt lgkmcnt(0)
    v_cmp_gt_i32 vcc, 4, v2
    s_cbranch_vccnz f_w12
f_s24:
    v_mfma_f32_32x32x16_bf16 v[48:63], v[96:99], v[112:115], 0
    ds_read_b128 v[100:103], v11 offset:14592
    ds_read_b32 v106, v12 offset:14592
    v_exp_f32 v32, v32
    v_exp_f32 v33, v33
    v_exp_f32 v34, v34
    v_exp_f32 v35, v35
    v_mfma_f32_32x32x8_bf16 v[48:63], v[104:105], v[110:111], v[48:63]
    ds_read_b128 v[116:119], v13 offset:9728
    ds_read_b128 v[120:123], v13 offset:10368
    v_exp_f32 v36, v36
    v_exp_f32 v37, v37
    v_exp_f32 v38, v38
    v_exp_f32 v39, v39
    v_smfmac_f32_32x32x32_bf16 v[152:167], v[80:83], v[64:71], v3
    v_exp_f32 v40, v40
    v_exp_f32 v41, v41
    v_exp_f32 v42, v42
    v_exp_f32 v43, v43
    v_smfmac_f32_32x32x32_bf16 v[152:167], v[84:87], v[72:79], v3
    v_exp_f32 v44, v44
    v_exp_f32 v45, v45
    v_exp_f32 v46, v46
    v_exp_f32_e64 v47, v47
    s_waitcnt lgkmcnt(0)
f_s25:
    v_mfma_f32_32x32x16_bf16 v[64:79], v[100:103], v[4:7], 0
    v_exp_f32 v48, v48
    v_exp_f32 v49, v49
    v_exp_f32 v50, v50
    v_exp_f32 v51, v51
    v_mfma_f32_32x32x8_bf16 v[64:79], v[106:107], v[8:9], v[64:79]
    v_exp_f32 v52, v52
    v_exp_f32 v53, v53
    v_exp_f32 v54, v54
    v_exp_f32 v55, v55
    v_smfmac_f32_32x32x32_bf16 v[136:151], v[116:119], v[32:39], v3
    v_exp_f32 v56, v56
    v_exp_f32 v57, v57
    v_exp_f32 v58, v58
    v_exp_f32 v59, v59
    v_smfmac_f32_32x32x32_bf16 v[136:151], v[120:123], v[40:47], v3
    v_exp_f32 v60, v60
    v_exp_f32 v61, v61
    v_exp_f32 v62, v62
    v_exp_f32 v63, v63
f_s26:
    v_mfma_f32_32x32x16_bf16 v[32:47], v[100:103], v[112:115], 0
    ds_read_b128 v[96:99], v11 offset:19456
    ds_read_b32 v104, v12 offset:19456
    v_exp_f32 v64, v64
    v_exp_f32 v65, v65
    v_exp_f32 v66, v66
    v_exp_f32 v67, v67
    v_mfma_f32_32x32x8_bf16 v[32:47], v[106:107], v[110:111], v[32:47]
    ds_read_b128 v[80:83], v13 offset:14592
    ds_read_b128 v[84:87], v13 offset:15232
    v_exp_f32 v68, v68
    v_exp_f32 v69, v69
    v_exp_f32 v70, v70
    v_exp_f32 v71, v71
    v_smfmac_f32_32x32x32_bf16 v[152:167], v[116:119], v[48:55], v3
    v_exp_f32 v72, v72
    v_exp_f32 v73, v73
    v_exp_f32 v74, v74
    v_exp_f32 v75, v75
    v_smfmac_f32_32x32x32_bf16 v[152:167], v[120:123], v[56:63], v3
    v_exp_f32 v76, v76
    v_exp_f32 v77, v77
    v_exp_f32 v78, v78
    v_exp_f32_e64 v79, v79
    s_waitcnt lgkmcnt(0)
f_s27:
    v_mfma_f32_32x32x16_bf16 v[48:63], v[96:99], v[4:7], 0
    v_exp_f32 v32, v32
    v_exp_f32 v33, v33
    v_exp_f32 v34, v34
    v_exp_f32 v35, v35
    v_mfma_f32_32x32x8_bf16 v[48:63], v[104:105], v[8:9], v[48:63]
    v_exp_f32 v36, v36
    v_exp_f32 v37, v37
    v_exp_f32 v38, v38
    v_exp_f32 v39, v39
    v_smfmac_f32_32x32x32_bf16 v[136:151], v[80:83], v[64:71], v3
    v_exp_f32 v40, v40
    v_exp_f32 v41, v41
    v_exp_f32 v42, v42
    v_exp_f32 v43, v43
    v_smfmac_f32_32x32x32_bf16 v[136:151], v[84:87], v[72:79], v3
    v_exp_f32 v44, v44
    v_exp_f32 v45, v45
    v_exp_f32 v46, v46
    v_exp_f32 v47, v47
f_s28:
    v_mfma_f32_32x32x16_bf16 v[64:79], v[96:99], v[112:115], 0
    ds_read_b128 v[100:103], v11 offset:24320
    ds_read_b32 v106, v12 offset:24320
    v_exp_f32 v48, v48
    v_exp_f32 v49, v49
    v_exp_f32 v50, v50
    v_exp_f32 v51, v51
    v_mfma_f32_32x32x8_bf16 v[64:79], v[104:105], v[110:111], v[64:79]
    ds_read_b128 v[116:119], v13 offset:19456
    ds_read_b128 v[120:123], v13 offset:20096
    v_exp_f32 v52, v52
    v_exp_f32 v53, v53
    v_exp_f32 v54, v54
    v_exp_f32 v55, v55
    v_smfmac_f32_32x32x32_bf16 v[152:167], v[80:83], v[32:39], v3
    v_exp_f32 v56, v56
    v_exp_f32 v57, v57
    v_exp_f32 v58, v58
    v_exp_f32 v59, v59
    v_smfmac_f32_32x32x32_bf16 v[152:167], v[84:87], v[40:47], v3
    v_exp_f32 v60, v60
    v_exp_f32 v61, v61
    v_exp_f32 v62, v62
    v_exp_f32_e64 v63, v63
    s_waitcnt lgkmcnt(0)
f_s29:
    v_mfma_f32_32x32x16_bf16 v[32:47], v[100:103], v[4:7], 0
    v_exp_f32 v64, v64
    v_exp_f32 v65, v65
    v_exp_f32 v66, v66
    v_exp_f32 v67, v67
    v_mfma_f32_32x32x8_bf16 v[32:47], v[106:107], v[8:9], v[32:47]
    v_exp_f32 v68, v68
    v_exp_f32 v69, v69
    v_exp_f32 v70, v70
    v_exp_f32 v71, v71
    v_smfmac_f32_32x32x32_bf16 v[136:151], v[116:119], v[48:55], v3
    v_exp_f32 v72, v72
    v_exp_f32 v73, v73
    v_exp_f32 v74, v74
    v_exp_f32 v75, v75
    v_smfmac_f32_32x32x32_bf16 v[136:151], v[120:123], v[56:63], v3
    v_exp_f32 v76, v76
    v_exp_f32 v77, v77
    v_exp_f32 v78, v78
    v_exp_f32 v79, v79
f_s30:
    v_mfma_f32_32x32x16_bf16 v[48:63], v[100:103], v[112:115], 0
    ds_read_b128 v[96:99], v11 offset:29184
    ds_read_b32 v104, v12 offset:29184
    v_exp_f32 v32, v32
    v_exp_f32 v33, v33
    v_exp_f32 v34, v34
    v_exp_f32 v35, v35
    v_mfma_f32_32x32x8_bf16 v[48:63], v[106:107], v[110:111], v[48:63]
    ds_read_b128 v[80:83], v13 offset:24320
    ds_read_b128 v[84:87], v13 offset:24960
    v_exp_f32 v36, v36
    v_exp_f32 v37, v37
    v_exp_f32 v38, v38
    v_exp_f32 v39, v39
    v_smfmac_f32_32x32x32_bf16 v[152:167], v[116:119], v[64:71], v3
    v_exp_f32 v40, v40
    v_exp_f32 v41, v41
    v_exp_f32 v42, v42
    v_exp_f32 v43, v43
    v_smfmac_f32_32x32x32_bf16 v[152:167], v[120:123], v[72:79], v3
    v_exp_f32 v44, v44
    v_exp_f32 v45, v45
    v_exp_f32 v46, v46
    v_exp_f32_e64 v47, v47
    s_waitcnt lgkmcnt(0)
f_s31:
    v_mfma_f32_32x32x16_bf16 v[64:79], v[96:99], v[4:7], 0
    v_exp_f32 v48, v48
    v_exp_f32 v49, v49
    v_exp_f32 v50, v50
    v_exp_f32 v51, v51
    v_mfma_f32_32x32x8_bf16 v[64:79], v[104:105], v[8:9], v[64:79]
    v_exp_f32 v52, v52
    v_exp_f32 v53, v53
    v_exp_f32 v54, v54
    v_exp_f32 v55, v55
    v_smfmac_f32_32x32x32_bf16 v[136:151], v[80:83], v[32:39], v3
    v_exp_f32 v56, v56
    v_exp_f32 v57, v57
    v_exp_f32 v58, v58
    v_exp_f32 v59, v59
    v_smfmac_f32_32x32x32_bf16 v[136:151], v[84:87], v[40:47], v3
    v_exp_f32 v60, v60
    v_exp_f32 v61, v61
    v_exp_f32 v62, v62
    v_exp_f32 v63, v63
    s_setprio 1
    v_mov_b32 v15, 5
    ds_write_b32 v109, v15
f_s32:
    v_mfma_f32_32x32x16_bf16 v[32:47], v[96:99], v[112:115], 0
    ds_read_b128 v[100:103], v11 offset:34048
    ds_read_b32 v106, v12 offset:34048
    v_exp_f32 v64, v64
    v_exp_f32 v65, v65
    v_exp_f32 v66, v66
    v_exp_f32 v67, v67
    v_mfma_f32_32x32x8_bf16 v[32:47], v[104:105], v[110:111], v[32:47]
    ds_read_b128 v[116:119], v13 offset:29184
    ds_read_b128 v[120:123], v13 offset:29824
    v_exp_f32 v68, v68
    v_exp_f32 v69, v69
    v_exp_f32 v70, v70
    v_exp_f32 v71, v71
    v_smfmac_f32_32x32x32_bf16 v[152:167], v[80:83], v[48:55], v3
    v_exp_f32 v72, v72
    v_exp_f32 v73, v73
    v_exp_f32 v74, v74
    v_exp_f32 v75, v75
    v_smfmac_f32_32x32x32_bf16 v[152:167], v[84:87], v[56:63], v3
    v_exp_f32 v76, v76
    v_exp_f32 v77, v77
    v_exp_f32 v78, v78
    v_exp_f32_e64 v79, v79
    s_waitcnt lgkmcnt(0)
f_s33:
    v_mfma_f32_32x32x16_bf16 v[48:63], v[100:103], v[4:7], 0
    v_exp_f32 v32, v32
    v_exp_f32 v33, v33
    v_exp_f32 v34, v34
    v_exp_f32 v35, v35
    v_mfma_f32_32x32x8_bf16 v[48:63], v[106:107], v[8:9], v[48:63]
    v_exp_f32 v36, v36
    v_exp_f32 v37, v37
    v_exp_f32 v38, v38
    v_exp_f32 v39, v39
    v_smfmac_f32_32x32x32_bf16 v[136:151], v[116:119], v[64:71], v3
    v_exp_f32 v40, v40
    v_exp_f32 v41, v41
    v_exp_f32 v42, v42
    v_exp_f32 v43, v43
    v_smfmac_f32_32x32x32_bf16 v[136:151], v[120:123], v[72:79], v3
    v_exp_f32 v44, v44
    v_exp_f32 v45, v45
    v_exp_f32 v46, v46
    v_exp_f32 v47, v47
f_s34:
    v_mfma_f32_32x32x16_bf16 v[64:79], v[100:103], v[112:115], 0
    ds_read_b128 v[96:99], v11 offset:38912
    ds_read_b32 v104, v12 offset:38912
    v_exp_f32 v48, v48
    v_exp_f32 v49, v49
    v_exp_f32 v50, v50
    v_exp_f32 v51, v51
    v_mfma_f32_32x32x8_bf16 v[64:79], v[106:107], v[110:111], v[64:79]
    ds_read_b128 v[80:83], v13 offset:34048
    ds_read_b128 v[84:87], v13 offset:34688
    v_exp_f32 v52, v52
    v_exp_f32 v53, v53
    v_exp_f32 v54, v54
    v_exp_f32 v55, v55
    v_smfmac_f32_32x32x32_bf16 v[152:167], v[116:119], v[32:39], v3
    v_exp_f32 v56, v56
    v_exp_f32 v57, v57
    v_exp_f32 v58, v58
    v_exp_f32 v59, v59
    v_smfmac_f32_32x32x32_bf16 v[152:167], v[120:123], v[40:47], v3
    v_exp_f32 v60, v60
    v_exp_f32 v61, v61
    v_exp_f32 v62, v62
    v_exp_f32_e64 v63, v63
    s_waitcnt lgkmcnt(0)
f_s35:
    v_mfma_f32_32x32x16_bf16 v[32:47], v[96:99], v[4:7], 0
    v_exp_f32 v64, v64
    v_exp_f32 v65, v65
    v_exp_f32 v66, v66
    v_exp_f32 v67, v67
    v_mfma_f32_32x32x8_bf16 v[32:47], v[104:105], v[8:9], v[32:47]
    v_exp_f32 v68, v68
    v_exp_f32 v69, v69
    v_exp_f32 v70, v70
    v_exp_f32 v71, v71
    v_smfmac_f32_32x32x32_bf16 v[136:151], v[80:83], v[48:55], v3
    v_exp_f32 v72, v72
    v_exp_f32 v73, v73
    v_exp_f32 v74, v74
    v_exp_f32 v75, v75
    v_smfmac_f32_32x32x32_bf16 v[136:151], v[84:87], v[56:63], v3
    v_exp_f32 v76, v76
    v_exp_f32 v77, v77
    v_exp_f32 v78, v78
    v_exp_f32 v79, v79
f_s36:
    v_mfma_f32_32x32x16_bf16 v[48:63], v[96:99], v[112:115], 0
    ds_read_b128 v[100:103], v11 offset:43776
    ds_read_b32 v106, v12 offset:43776
    v_exp_f32 v32, v32
    v_exp_f32 v33, v33
    v_exp_f32 v34, v34
    v_exp_f32 v35, v35
    v_mfma_f32_32x32x8_bf16 v[48:63], v[104:105], v[110:111], v[48:63]
    ds_read_b128 v[116:119], v13 offset:38912
    ds_read_b128 v[120:123], v13 offset:39552
    v_exp_f32 v36, v36
    v_exp_f32 v37, v37
    v_exp_f32 v38, v38
    v_exp_f32 v39, v39
    v_smfmac_f32_32x32x32_bf16 v[152:167], v[80:83], v[64:71], v3
    v_exp_f32 v40, v40
    v_exp_f32 v41, v41
    v_exp_f32 v42, v42
    v_exp_f32 v43, v43
    v_smfmac_f32_32x32x32_bf16 v[152:167], v[84:87], v[72:79], v3
    v_exp_f32 v44, v44
    v_exp_f32 v45, v45
    v_exp_f32 v46, v46
    v_exp_f32_e64 v47, v47
    s_waitcnt lgkmcnt(0)
f_s37:
    v_mfma_f32_32x32x16_bf16 v[64:79], v[100:103], v[4:7], 0
    v_exp_f32 v48, v48
    v_exp_f32 v49, v49
    v_exp_f32 v50, v50
    v_exp_f32 v51, v51
    v_mfma_f32_32x32x8_bf16 v[64:79], v[106:107], v[8:9], v[64:79]
    v_exp_f32 v52, v52
    v_exp_f32 v53, v53
    v_exp_f32 v54, v54
    v_exp_f32 v55, v55
    v_smfmac_f32_32x32x32_bf16 v[136:151], v[116:119], v[32:39], v3
    v_exp_f32 v56, v56
    v_exp_f32 v57, v57
    v_exp_f32 v58, v58
    v_exp_f32 v59, v59
    v_smfmac_f32_32x32x32_bf16 v[136:151], v[120:123], v[40:47], v3
    v_exp_f32 v60, v60
    v_exp_f32 v61, v61
    v_exp_f32 v62, v62
    v_exp_f32_e64 v63, v63
f_w19:
    ds_read_b32 v2, v108
    s_waitcnt lgkmcnt(0)
    v_cmp_gt_i32 vcc, 5, v2
    s_cbranch_vccnz f_w19
f_s38:
    v_mfma_f32_32x32x16_bf16 v[32:47], v[100:103], v[112:115], 0
    ds_read_b128 v[96:99], v11 offset:48640
    ds_read_b32 v104, v12 offset:48640
    v_exp_f32 v64, v64
    v_exp_f32 v65, v65
    v_exp_f32 v66, v66
    v_exp_f32 v67, v67
    v_mfma_f32_32x32x8_bf16 v[32:47], v[106:107], v[110:111], v[32:47]
    ds_read_b128 v[80:83], v13 offset:43776
    ds_read_b128 v[84:87], v13 offset:44416
    v_exp_f32 v68, v68
    v_exp_f32 v69, v69
    v_exp_f32 v70, v70
    v_exp_f32 v71, v71
    v_smfmac_f32_32x32x32_bf16 v[152:167], v[116:119], v[48:55], v3
    v_exp_f32 v72, v72
    v_exp_f32 v73, v73
    v_exp_f32 v74, v74
    v_exp_f32 v75, v75
    v_smfmac_f32_32x32x32_bf16 v[152:167], v[120:123], v[56:63], v3
    v_exp_f32 v76, v76
    v_exp_f32 v77, v77
    v_exp_f32 v78, v78
    v_exp_f32_e64 v79, v79
    s_waitcnt lgkmcnt(0)
f_s39:
    v_mfma_f32_32x32x16_bf16 v[48:63], v[96:99], v[4:7], 0
    v_exp_f32 v32, v32
    v_exp_f32 v33, v33
    v_exp_f32 v34, v34
    v_exp_f32 v35, v35
    v_mfma_f32_32x32x8_bf16 v[48:63], v[104:105], v[8:9], v[48:63]
    v_exp_f32 v36, v36
    v_exp_f32 v37, v37
    v_exp_f32 v38, v38
    v_exp_f32 v39, v39
    v_smfmac_f32_32x32x32_bf16 v[136:151], v[80:83], v[64:71], v3
    v_exp_f32 v40, v40
    v_exp_f32 v41, v41
    v_exp_f32 v42, v42
    v_exp_f32 v43, v43
    v_smfmac_f32_32x32x32_bf16 v[136:151], v[84:87], v[72:79], v3
    v_exp_f32 v44, v44
    v_exp_f32 v45, v45
    v_exp_f32 v46, v46
    v_exp_f32 v47, v47
f_s40:
    v_mfma_f32_32x32x16_bf16 v[64:79], v[96:99], v[112:115], 0
    ds_read_b128 v[100:103], v11 offset:53504
    ds_read_b32 v106, v12 offset:53504
    v_exp_f32 v48, v48
    v_exp_f32 v49, v49
    v_exp_f32 v50, v50
    v_exp_f32 v51, v51
    v_mfma_f32_32x32x8_bf16 v[64:79], v[104:105], v[110:111], v[64:79]
    ds_read_b128 v[116:119], v13 offset:48640
    ds_read_b128 v[120:123], v13 offset:49280
    v_exp_f32 v52, v52
    v_exp_f32 v53, v53
    v_exp_f32 v54, v54
    v_exp_f32 v55, v55
    v_smfmac_f32_32x32x32_bf16 v[152:167], v[80:83], v[32:39], v3
    v_exp_f32 v56, v56
    v_exp_f32 v57, v57
    v_exp_f32 v58, v58
    v_exp_f32 v59, v59
    v_smfmac_f32_32x32x32_bf16 v[152:167], v[84:87], v[40:47], v3
    v_exp_f32 v60, v60
    v_exp_f32 v61, v61
    v_exp_f32 v62, v62
    v_exp_f32_e64 v63, v63
    s_waitcnt lgkmcnt(0)
f_s41:
    v_mfma_f32_32x32x16_bf16 v[32:47], v[100:103], v[4:7], 0
    v_exp_f32 v64, v64
    v_exp_f32 v65, v65
    v_exp_f32 v66, v66
    v_exp_f32 v67, v67
    v_mfma_f32_32x32x8_bf16 v[32:47], v[106:107], v[8:9], v[32:47]
    v_exp_f32 v68, v68
    v_exp_f32 v69, v69
    v_exp_f32 v70, v70
    v_exp_f32 v71, v71
    v_smfmac_f32_32x32x32_bf16 v[136:151], v[116:119], v[48:55], v3
    v_exp_f32 v72, v72
    v_exp_f32 v73, v73
    v_exp_f32 v74, v74
    v_exp_f32 v75, v75
    v_smfmac_f32_32x32x32_bf16 v[136:151], v[120:123], v[56:63], v3
    v_exp_f32 v76, v76
    v_exp_f32 v77, v77
    v_exp_f32 v78, v78
    v_exp_f32 v79, v79
f_s42:
    v_mfma_f32_32x32x16_bf16 v[48:63], v[100:103], v[112:115], 0
    ds_read_b128 v[96:99], v11 offset:58368
    ds_read_b32 v104, v12 offset:58368
    v_exp_f32 v32, v32
    v_exp_f32 v33, v33
    v_exp_f32 v34, v34
    v_exp_f32 v35, v35
    v_mfma_f32_32x32x8_bf16 v[48:63], v[106:107], v[110:111], v[48:63]
    ds_read_b128 v[80:83], v13 offset:53504
    ds_read_b128 v[84:87], v13 offset:54144
    v_exp_f32 v36, v36
    v_exp_f32 v37, v37
    v_exp_f32 v38, v38
    v_exp_f32 v39, v39
    v_smfmac_f32_32x32x32_bf16 v[152:167], v[116:119], v[64:71], v3
    v_exp_f32 v40, v40
    v_exp_f32 v41, v41
    v_exp_f32 v42, v42
    v_exp_f32 v43, v43
    v_smfmac_f32_32x32x32_bf16 v[152:167], v[120:123], v[72:79], v3
    v_exp_f32 v44, v44
    v_exp_f32 v45, v45
    v_exp_f32 v46, v46
    v_exp_f32_e64 v47, v47
    s_waitcnt lgkmcnt(0)
f_s43:
    v_mfma_f32_32x32x16_bf16 v[64:79], v[96:99], v[4:7], 0
    v_exp_f32 v48, v48
    v_exp_f32 v49, v49
    v_exp_f32 v50, v50
    v_exp_f32 v51, v51
    v_mfma_f32_32x32x8_bf16 v[64:79], v[104:105], v[8:9], v[64:79]
    v_exp_f32 v52, v52
    v_exp_f32 v53, v53
    v_exp_f32 v54, v54
    v_exp_f32 v55, v55
    v_smfmac_f32_32x32x32_bf16 v[136:151], v[80:83], v[32:39], v3
    v_exp_f32 v56, v56
    v_exp_f32 v57, v57
    v_exp_f32 v58, v58
    v_exp_f32 v59, v59
    v_smfmac_f32_32x32x32_bf16 v[136:151], v[84:87], v[40:47], v3
    v_exp_f32 v60, v60
    v_exp_f32 v61, v61
    v_exp_f32 v62, v62
    v_exp_f32_e64 v63, v63
    v_mov_b32 v15, 6
    ds_write_b32 v109, v15
f_s44:
    v_mfma_f32_32x32x16_bf16 v[32:47], v[96:99], v[112:115], 0
    ds_read_b128 v[100:103], v11 offset:63232
    ds_read_b32 v106, v12 offset:63232
    v_exp_f32 v64, v64
    v_exp_f32 v65, v65
    v_exp_f32 v66, v66
    v_exp_f32 v67, v67
    v_mfma_f32_32x32x8_bf16 v[32:47], v[104:105], v[110:111], v[32:47]
    ds_read_b128 v[116:119], v13 offset:58368
    ds_read_b128 v[120:123], v13 offset:59008
    v_exp_f32 v68, v68
    v_exp_f32 v69, v69
    v_exp_f32 v70, v70
    v_exp_f32 v71, v71
    v_smfmac_f32_32x32x32_bf16 v[152:167], v[80:83], v[48:55], v3
    v_exp_f32 v72, v72
    v_exp_f32 v73, v73
    v_exp_f32 v74, v74
    v_exp_f32 v75, v75
    v_smfmac_f32_32x32x32_bf16 v[152:167], v[84:87], v[56:63], v3
    v_exp_f32 v76, v76
    v_exp_f32 v77, v77
    v_exp_f32 v78, v78
    v_exp_f32_e64 v79, v79
    s_waitcnt lgkmcnt(0)
f_s45:
    v_mfma_f32_32x32x16_bf16 v[48:63], v[100:103], v[4:7], 0
    v_exp_f32 v32, v32
    v_exp_f32 v33, v33
    v_exp_f32 v34, v34
    v_exp_f32 v35, v35
    v_mfma_f32_32x32x8_bf16 v[48:63], v[106:107], v[8:9], v[48:63]
    v_exp_f32 v36, v36
    v_exp_f32 v37, v37
    v_exp_f32 v38, v38
    v_exp_f32 v39, v39
    v_smfmac_f32_32x32x32_bf16 v[136:151], v[116:119], v[64:71], v3
    v_exp_f32 v40, v40
    v_exp_f32 v41, v41
    v_exp_f32 v42, v42
    v_exp_f32 v43, v43
    v_smfmac_f32_32x32x32_bf16 v[136:151], v[120:123], v[72:79], v3
    v_exp_f32 v44, v44
    v_exp_f32 v45, v45
    v_exp_f32 v46, v46
    v_exp_f32 v47, v47
    v_add_u32 v11, 68096, v11
    v_add_u32 v12, 68096, v12
f_s46:
    v_mfma_f32_32x32x16_bf16 v[64:79], v[100:103], v[112:115], 0
    ds_read_b128 v[96:99], v11 offset:0
    ds_read_b32 v104, v12 offset:0
    v_exp_f32 v48, v48
    v_exp_f32 v49, v49
    v_exp_f32 v50, v50
    v_exp_f32 v51, v51
    v_mfma_f32_32x32x8_bf16 v[64:79], v[106:107], v[110:111], v[64:79]
    ds_read_b128 v[80:83], v13 offset:63232
    ds_read_b128 v[84:87], v13 offset:63872
    v_exp_f32 v52, v52
    v_exp_f32 v53, v53
    v_exp_f32 v54, v54
    v_exp_f32 v55, v55
    v_smfmac_f32_32x32x32_bf16 v[152:167], v[116:119], v[32:39], v3
    v_exp_f32 v56, v56
    v_exp_f32 v57, v57
    v_exp_f32 v58, v58
    v_exp_f32 v59, v59
    v_smfmac_f32_32x32x32_bf16 v[152:167], v[120:123], v[40:47], v3
    v_exp_f32 v60, v60
    v_exp_f32 v61, v61
    v_exp_f32 v62, v62
    v_exp_f32_e64 v63, v63
    s_waitcnt lgkmcnt(0)
f_s47:
    v_mfma_f32_32x32x16_bf16 v[32:47], v[96:99], v[4:7], 0
    v_exp_f32 v64, v64
    v_exp_f32 v65, v65
    v_exp_f32 v66, v66
    v_exp_f32 v67, v67
    v_mfma_f32_32x32x8_bf16 v[32:47], v[104:105], v[8:9], v[32:47]
    v_exp_f32 v68, v68
    v_exp_f32 v69, v69
    v_exp_f32 v70, v70
    v_exp_f32 v71, v71
    v_smfmac_f32_32x32x32_bf16 v[136:151], v[80:83], v[48:55], v3
    v_exp_f32 v72, v72
    v_exp_f32 v73, v73
    v_exp_f32 v74, v74
    v_exp_f32 v75, v75
    v_smfmac_f32_32x32x32_bf16 v[136:151], v[84:87], v[56:63], v3
    v_exp_f32 v76, v76
    v_exp_f32 v77, v77
    v_exp_f32 v78, v78
    v_exp_f32 v79, v79
    v_add_u32 v13, 68096, v13
f_s48:
    v_mfma_f32_32x32x16_bf16 v[48:63], v[96:99], v[112:115], 0
    ds_read_b128 v[100:103], v11 offset:4864
    ds_read_b32 v106, v12 offset:4864
    v_exp_f32 v32, v32
    v_exp_f32 v33, v33
    v_exp_f32 v34, v34
    v_exp_f32 v35, v35
    v_mfma_f32_32x32x8_bf16 v[48:63], v[104:105], v[110:111], v[48:63]
    ds_read_b128 v[116:119], v13 offset:0
    ds_read_b128 v[120:123], v13 offset:640
    v_exp_f32 v36, v36
    v_exp_f32 v37, v37
    v_exp_f32 v38, v38
    v_exp_f32 v39, v39
    v_smfmac_f32_32x32x32_bf16 v[152:167], v[80:83], v[64:71], v3
    v_exp_f32 v40, v40
    v_exp_f32 v41, v41
    v_exp_f32 v42, v42
    v_exp_f32 v43, v43
    v_smfmac_f32_32x32x32_bf16 v[152:167], v[84:87], v[72:79], v3
    v_exp_f32 v44, v44
    v_exp_f32 v45, v45
    v_exp_f32 v46, v46
    v_exp_f32_e64 v47, v47
    s_waitcnt lgkmcnt(0)
f_s49:
    v_mfma_f32_32x32x16_bf16 v[64:79], v[100:103], v[4:7], 0
    v_exp_f32 v48, v48
    v_exp_f32 v49, v49
    v_exp_f32 v50, v50
    v_exp_f32 v51, v51
    v_mfma_f32_32x32x8_bf16 v[64:79], v[106:107], v[8:9], v[64:79]
    v_exp_f32 v52, v52
    v_exp_f32 v53, v53
    v_exp_f32 v54, v54
    v_exp_f32 v55, v55
    v_smfmac_f32_32x32x32_bf16 v[136:151], v[116:119], v[32:39], v3
    v_exp_f32 v56, v56
    v_exp_f32 v57, v57
    v_exp_f32 v58, v58
    v_exp_f32 v59, v59
    v_smfmac_f32_32x32x32_bf16 v[136:151], v[120:123], v[40:47], v3
    v_exp_f32 v60, v60
    v_exp_f32 v61, v61
    v_exp_f32 v62, v62
    v_exp_f32_e64 v63, v63
    s_cmp_eq_u32 s71, 0
    s_cbranch_scc1 f_e0
    v_mov_b32 v108, 159824
f_e1:
    ds_read_b32 v2, v108
    s_waitcnt lgkmcnt(0)
    v_cmp_gt_i32 vcc, 1, v2
    s_cbranch_vccnz f_e1
    s_lshl_b32 s3, s72, 2
    s_add_u32 s3, s3, 159872
    v_mov_b32 v108, s3
    v_add_u32 v15, 160000, v129
    ds_read_b32 v10, v15 offset:128
    ds_read_b32 v14, v15 offset:0
f_e0:
f_s50:
    v_mfma_f32_32x32x16_bf16 v[32:47], v[100:103], v[112:115], 0
    ds_read_b128 v[96:99], v11 offset:9728
    ds_read_b32 v104, v12 offset:9728
    v_exp_f32 v64, v64
    v_exp_f32 v65, v65
    v_exp_f32 v66, v66
    v_exp_f32 v67, v67
    v_mfma_f32_32x32x8_bf16 v[32:47], v[106:107], v[110:111], v[32:47]
    ds_read_b128 v[80:83], v13 offset:4864
    ds_read_b128 v[84:87], v13 offset:5504
    v_exp_f32 v68, v68
    v_exp_f32 v69, v69
    v_exp_f32 v70, v70
    v_exp_f32 v71, v71
    v_smfmac_f32_32x32x32_bf16 v[152:167], v[116:119], v[48:55], v3
    v_exp_f32 v72, v72
    v_exp_f32 v73, v73
    v_exp_f32 v74, v74
    v_exp_f32 v75, v75
    v_smfmac_f32_32x32x32_bf16 v[152:167], v[120:123], v[56:63], v3
    v_exp_f32 v76, v76
    v_exp_f32 v77, v77
    v_exp_f32 v78, v78
    v_exp_f32_e64 v79, v79
    s_waitcnt lgkmcnt(0)
f_s51:
    v_mfma_f32_32x32x16_bf16 v[48:63], v[96:99], v[4:7], 0
    v_exp_f32 v32, v32
    v_exp_f32 v33, v33
    v_exp_f32 v34, v34
    v_exp_f32 v35, v35
    v_mfma_f32_32x32x8_bf16 v[48:63], v[104:105], v[8:9], v[48:63]
    v_exp_f32 v36, v36
    v_exp_f32 v37, v37
    v_exp_f32 v38, v38
    v_exp_f32 v39, v39
    v_smfmac_f32_32x32x32_bf16 v[136:151], v[80:83], v[64:71], v3
    v_exp_f32 v40, v40
    v_exp_f32 v41, v41
    v_exp_f32 v42, v42
    v_exp_f32 v43, v43
    v_smfmac_f32_32x32x32_bf16 v[136:151], v[84:87], v[72:79], v3
    v_exp_f32 v44, v44
    v_exp_f32 v45, v45
    v_exp_f32 v46, v46
    v_exp_f32 v47, v47
    v_sub_f32 v10, 1.0, v10
    v_sub_f32 v14, 1.0, v14
f_s52:
    v_mfma_f32_32x32x16_bf16 v[64:79], v[96:99], v[112:115], 0
    ds_read_b128 v[100:103], v11 offset:14592
    ds_read_b32 v106, v12 offset:14592
    v_exp_f32 v48, v48
    v_exp_f32 v49, v49
    v_exp_f32 v50, v50
    v_exp_f32 v51, v51
    v_mfma_f32_32x32x8_bf16 v[64:79], v[104:105], v[110:111], v[64:79]
    ds_read_b128 v[116:119], v13 offset:9728
    ds_read_b128 v[120:123], v13 offset:10368
    v_exp_f32 v52, v52
    v_exp_f32 v53, v53
    v_exp_f32 v54, v54
    v_exp_f32 v55, v55
    v_smfmac_f32_32x32x32_bf16 v[152:167], v[80:83], v[32:39], v3
    v_exp_f32 v56, v56
    v_exp_f32 v57, v57
    v_exp_f32 v58, v58
    v_exp_f32 v59, v59
    v_smfmac_f32_32x32x32_bf16 v[152:167], v[84:87], v[40:47], v3
    v_exp_f32 v60, v60
    v_exp_f32 v61, v61
    v_exp_f32 v62, v62
    v_exp_f32_e64 v63, v63
    s_waitcnt lgkmcnt(0)
f_s53:
    v_mfma_f32_32x32x16_bf16 v[32:47], v[100:103], v[4:7], 0
    v_exp_f32 v64, v64
    v_exp_f32 v65, v65
    v_exp_f32 v66, v66
    v_exp_f32 v67, v67
    v_mfma_f32_32x32x8_bf16 v[32:47], v[106:107], v[8:9], v[32:47]
    v_exp_f32 v68, v68
    v_exp_f32 v69, v69
    v_exp_f32 v70, v70
    v_exp_f32 v71, v71
    v_smfmac_f32_32x32x32_bf16 v[136:151], v[116:119], v[48:55], v3
    v_exp_f32 v72, v72
    v_exp_f32 v73, v73
    v_exp_f32 v74, v74
    v_exp_f32 v75, v75
    v_smfmac_f32_32x32x32_bf16 v[136:151], v[120:123], v[56:63], v3
    v_exp_f32 v76, v76
    v_exp_f32 v77, v77
    v_exp_f32 v78, v78
    v_exp_f32_e64 v79, v79
    v_mov_b32 v15, 7
    ds_write_b32 v109, v15
f_s54:
    v_mfma_f32_32x32x16_bf16 v[48:63], v[100:103], v[112:115], 0
    ds_read_b128 v[96:99], v11 offset:19456
    ds_read_b32 v104, v12 offset:19456
    v_exp_f32 v32, v32
    v_exp_f32 v33, v33
    v_exp_f32 v34, v34
    v_exp_f32 v35, v35
    v_mfma_f32_32x32x8_bf16 v[48:63], v[106:107], v[110:111], v[48:63]
    ds_read_b128 v[80:83], v13 offset:14592
    ds_read_b128 v[84:87], v13 offset:15232
    v_exp_f32 v36, v36
    v_exp_f32 v37, v37
    v_exp_f32 v38, v38
    v_exp_f32 v39, v39
    v_smfmac_f32_32x32x32_bf16 v[152:167], v[116:119], v[64:71], v3
    v_exp_f32 v40, v40
    v_exp_f32 v41, v41
    v_exp_f32 v42, v42
    v_exp_f32 v43, v43
    v_smfmac_f32_32x32x32_bf16 v[152:167], v[120:123], v[72:79], v3
    v_exp_f32 v44, v44
    v_exp_f32 v45, v45
    v_exp_f32 v46, v46
    v_exp_f32_e64 v47, v47
    s_waitcnt lgkmcnt(0)
f_s55:
    v_mfma_f32_32x32x16_bf16 v[64:79], v[96:99], v[4:7], 0
    v_exp_f32 v48, v48
    v_exp_f32 v49, v49
    v_exp_f32 v50, v50
    v_exp_f32 v51, v51
    v_mfma_f32_32x32x8_bf16 v[64:79], v[104:105], v[8:9], v[64:79]
    v_exp_f32 v52, v52
    v_exp_f32 v53, v53
    v_exp_f32 v54, v54
    v_exp_f32 v55, v55
    v_smfmac_f32_32x32x32_bf16 v[136:151], v[80:83], v[32:39], v3
    v_exp_f32 v56, v56
    v_exp_f32 v57, v57
    v_exp_f32 v58, v58
    v_exp_f32 v59, v59
    v_smfmac_f32_32x32x32_bf16 v[136:151], v[84:87], v[40:47], v3
    v_exp_f32 v60, v60
    v_exp_f32 v61, v61
    v_exp_f32 v62, v62
    v_exp_f32 v63, v63
f_s56:
    v_mfma_f32_32x32x16_bf16 v[32:47], v[96:99], v[112:115], 0
    ds_read_b128 v[100:103], v11 offset:24320
    ds_read_b32 v106, v12 offset:24320
    v_exp_f32 v64, v64
    v_exp_f32 v65, v65
    v_exp_f32 v66, v66
    v_exp_f32 v67, v67
    v_mfma_f32_32x32x8_bf16 v[32:47], v[104:105], v[110:111], v[32:47]
    ds_read_b128 v[116:119], v13 offset:19456
    ds_read_b128 v[120:123], v13 offset:20096
    v_exp_f32 v68, v68
    v_exp_f32 v69, v69
    v_exp_f32 v70, v70
    v_exp_f32 v71, v71
    v_smfmac_f32_32x32x32_bf16 v[152:167], v[80:83], v[48:55], v3
    v_exp_f32 v72, v72
    v_exp_f32 v73, v73
    v_exp_f32 v74, v74
    v_exp_f32 v75, v75
    v_smfmac_f32_32x32x32_bf16 v[152:167], v[84:87], v[56:63], v3
    v_exp_f32 v76, v76
    v_exp_f32 v77, v77
    v_exp_f32 v78, v78
    v_exp_f32_e64 v79, v79
    s_waitcnt lgkmcnt(0)
f_s57:
    v_mfma_f32_32x32x16_bf16 v[48:63], v[100:103], v[4:7], 0
    v_exp_f32 v32, v32
    v_exp_f32 v33, v33
    v_exp_f32 v34, v34
    v_exp_f32 v35, v35
    v_mfma_f32_32x32x8_bf16 v[48:63], v[106:107], v[8:9], v[48:63]
    v_exp_f32 v36, v36
    v_exp_f32 v37, v37
    v_exp_f32 v38, v38
    v_exp_f32 v39, v39
    v_smfmac_f32_32x32x32_bf16 v[136:151], v[116:119], v[64:71], v3
    v_exp_f32 v40, v40
    v_exp_f32 v41, v41
    v_exp_f32 v42, v42
    v_exp_f32 v43, v43
    v_smfmac_f32_32x32x32_bf16 v[136:151], v[120:123], v[72:79], v3
    v_exp_f32 v44, v44
    v_exp_f32 v45, v45
    v_exp_f32 v46, v46
    v_exp_f32_e64 v47, v47
    s_setprio 0
f_s58:
    v_mfma_f32_32x32x16_bf16 v[64:79], v[100:103], v[112:115], 0
    ds_read_b128 v[96:99], v11 offset:29184
    ds_read_b32 v104, v12 offset:29184
    v_exp_f32 v48, v48
    v_exp_f32 v49, v49
    v_exp_f32 v50, v50
    v_exp_f32 v51, v51
    v_mfma_f32_32x32x8_bf16 v[64:79], v[106:107], v[110:111], v[64:79]
    ds_read_b128 v[80:83], v13 offset:24320
    ds_read_b128 v[84:87], v13 offset:24960
    v_exp_f32 v52, v52
    v_exp_f32 v53, v53
    v_exp_f32 v54, v54
    v_exp_f32 v55, v55
    v_smfmac_f32_32x32x32_bf16 v[152:167], v[116:119], v[32:39], v3
    v_exp_f32 v56, v56
    v_exp_f32 v57, v57
    v_exp_f32 v58, v58
    v_exp_f32 v59, v59
    v_smfmac_f32_32x32x32_bf16 v[152:167], v[120:123], v[40:47], v3
    v_exp_f32 v60, v60
    v_exp_f32 v61, v61
    v_exp_f32 v62, v62
    v_exp_f32_e64 v63, v63
    s_waitcnt lgkmcnt(0)
f_s59:
    v_mfma_f32_32x32x16_bf16 v[32:47], v[96:99], v[4:7], 0
    v_exp_f32 v64, v64
    v_exp_f32 v65, v65
    v_exp_f32 v66, v66
    v_exp_f32 v67, v67
    v_mfma_f32_32x32x8_bf16 v[32:47], v[104:105], v[8:9], v[32:47]
    v_exp_f32 v68, v68
    v_exp_f32 v69, v69
    v_exp_f32 v70, v70
    v_exp_f32 v71, v71
    v_smfmac_f32_32x32x32_bf16 v[136:151], v[80:83], v[48:55], v3
    v_exp_f32 v72, v72
    v_exp_f32 v73, v73
    v_exp_f32 v74, v74
    v_exp_f32 v75, v75
    v_smfmac_f32_32x32x32_bf16 v[136:151], v[84:87], v[56:63], v3
    v_exp_f32 v76, v76
    v_exp_f32 v77, v77
    v_exp_f32 v78, v78
    v_exp_f32 v79, v79
f_s60:
    v_mfma_f32_32x32x16_bf16 v[48:63], v[96:99], v[112:115], 0
    ds_read_b128 v[100:103], v11 offset:34048
    ds_read_b32 v106, v12 offset:34048
    v_exp_f32 v32, v32
    v_exp_f32 v33, v33
    v_exp_f32 v34, v34
    v_exp_f32 v35, v35
    v_mfma_f32_32x32x8_bf16 v[48:63], v[104:105], v[110:111], v[48:63]
    ds_read_b128 v[116:119], v13 offset:29184
    ds_read_b128 v[120:123], v13 offset:29824
    v_exp_f32 v36, v36
    v_exp_f32 v37, v37
    v_exp_f32 v38, v38
    v_exp_f32 v39, v39
    v_smfmac_f32_32x32x32_bf16 v[152:167], v[80:83], v[64:71], v3
    v_exp_f32 v40, v40
    v_exp_f32 v41, v41
    v_exp_f32 v42, v42
    v_exp_f32 v43, v43
    v_smfmac_f32_32x32x32_bf16 v[152:167], v[84:87], v[72:79], v3
    v_exp_f32 v44, v44
    v_exp_f32 v45, v45
    v_exp_f32 v46, v46
    v_exp_f32_e64 v47, v47
    s_waitcnt lgkmcnt(0)
f_s61:
    v_mfma_f32_32x32x16_bf16 v[64:79], v[100:103], v[4:7], 0
    v_exp_f32 v48, v48
    v_exp_f32 v49, v49
    v_exp_f32 v50, v50
    v_exp_f32 v51, v51
    v_mfma_f32_32x32x8_bf16 v[64:79], v[106:107], v[8:9], v[64:79]
    v_exp_f32 v52, v52
    v_exp_f32 v53, v53
    v_exp_f32 v54, v54
    v_exp_f32 v55, v55
    v_smfmac_f32_32x32x32_bf16 v[136:151], v[116:119], v[32:39], v3
    v_exp_f32 v56, v56
    v_exp_f32 v57, v57
    v_exp_f32 v58, v58
    v_exp_f32 v59, v59
    v_smfmac_f32_32x32x32_bf16 v[136:151], v[120:123], v[40:47], v3
    v_exp_f32 v60, v60
    v_exp_f32 v61, v61
    v_exp_f32 v62, v62
    v_exp_f32 v63, v63
    ds_read_b32 v2, v108
f_s62:
    v_mfma_f32_32x32x16_bf16 v[32:47], v[100:103], v[112:115], 0
    v_exp_f32 v64, v64
    v_exp_f32 v65, v65
    v_exp_f32 v66, v66
    v_exp_f32 v67, v67
    v_mfma_f32_32x32x8_bf16 v[32:47], v[106:107], v[110:111], v[32:47]
    ds_read_b128 v[80:83], v13 offset:34048
    ds_read_b128 v[84:87], v13 offset:34688
    v_exp_f32 v68, v68
    v_exp_f32 v69, v69
    v_exp_f32 v70, v70
    v_exp_f32 v71, v71
    v_smfmac_f32_32x32x32_bf16 v[152:167], v[116:119], v[48:55], v3
    v_exp_f32 v72, v72
    v_exp_f32 v73, v73
    v_exp_f32 v74, v74
    v_exp_f32 v75, v75
    v_smfmac_f32_32x32x32_bf16 v[152:167], v[120:123], v[56:63], v3
    v_exp_f32 v76, v76
    v_exp_f32 v77, v77
    v_exp_f32 v78, v78
    v_exp_f32 v79, v79
    s_waitcnt lgkmcnt(0)
    s_cmp_eq_u32 s71, 0
    s_cbranch_scc1 f_e5
    v_cmp_gt_i32 vcc, 1, v2
    s_cbranch_vccz f_e2_ok
f_e2:
    ds_read_b32 v2, v108
    s_waitcnt lgkmcnt(0)
    v_cmp_gt_i32 vcc, 1, v2
    s_cbranch_vccnz f_e2
f_e2_ok:
    ds_read_b128 v[16:19], v131 offset:0
    ds_read_b128 v[20:23], v131 offset:1024
    ds_read_b128 v[24:27], v131 offset:2048
    ds_read_b128 v[28:31], v131 offset:3072
    ds_read_b128 v[88:91], v131 offset:4096
    ds_read_b128 v[92:95], v131 offset:5120
f_e5:
f_s63:
    v_exp_f32 v32, v32
    v_exp_f32 v33, v33
    v_exp_f32 v34, v34
    v_exp_f32 v35, v35
    v_exp_f32 v36, v36
    v_exp_f32 v37, v37
    v_exp_f32 v38, v38
    v_exp_f32 v39, v39
    v_smfmac_f32_32x32x32_bf16 v[136:151], v[80:83], v[64:71], v3
    v_exp_f32 v40, v40
    v_exp_f32 v41, v41
    v_exp_f32 v42, v42
    v_exp_f32 v43, v43
    v_smfmac_f32_32x32x32_bf16 v[136:151], v[84:87], v[72:79], v3
    v_exp_f32 v44, v44
    v_exp_f32 v45, v45
    v_exp_f32 v46, v46
    v_exp_f32 v47, v47
    s_nop 1
    v_smfmac_f32_32x32x32_bf16 v[152:167], v[80:83], v[32:39], v3
    v_smfmac_f32_32x32x32_bf16 v[152:167], v[84:87], v[40:47], v3
    s_cmp_lg_u32 s71, 0
    s_cbranch_scc1 f_e3
    v_and_b32 v14, 28, v129
    v_add_u32 v14, 159760, v14
    s_lshl_b32 s3, s72, 2
    s_add_u32 s3, s3, 159872
    v_mov_b32 v108, s3
    v_mov_b32 v3, 1
f_e4:
    ds_read_b32 v15, v14
    s_waitcnt lgkmcnt(0)
    v_cmp_gt_i32 vcc, 7, v15
    s_cbranch_vccnz f_e4
    s_nop 3
    ds_write_b128 v131, v[136:139] offset:0
    ds_write_b128 v131, v[140:143] offset:1024
    ds_write_b128 v131, v[144:147] offset:2048
    ds_write_b128 v131, v[152:155] offset:3072
    ds_write_b128 v131, v[156:159] offset:4096
    ds_write_b128 v131, v[160:163] offset:5120
    ds_write_b32 v108, v3
    s_endpgm
f_e3:
    s_waitcnt lgkmcnt(0)
    s_nop 0
    v_add_f32 v136, v136, v28
    v_add_f32 v137, v137, v29
    v_add_f32 v138, v138, v30
    v_add_f32 v139, v139, v31
    v_add_f32 v140, v140, v88
    v_add_f32 v141, v141, v89
    v_add_f32 v142, v142, v90
    v_add_f32 v143, v143, v91
    v_add_f32 v144, v144, v92
    v_add_f32 v145, v145, v93
    v_add_f32 v146, v146, v94
    v_mov_b32 v58, v146
    s_nop 1
    v_permlane32_swap_b32 v146, v58
    v_rcp_f32 v58, v146
    s_nop 0
    v_mul_f32 v58, v58, v10
    v_mul_f32 v48, v136, v58
    v_mul_f32 v49, v137, v58
    v_mul_f32 v50, v138, v58
    v_mul_f32 v51, v139, v58
    v_mul_f32 v52, v140, v58
    v_mul_f32 v53, v141, v58
    v_mul_f32 v54, v142, v58
    v_mul_f32 v55, v143, v58
    v_mul_f32 v56, v144, v58
    v_mul_f32 v57, v145, v58
    v_cvt_pk_bf16_f32 v64, v48, v49
    v_cvt_pk_bf16_f32 v65, v50, v51
    v_cvt_pk_bf16_f32 v66, v52, v53
    v_cvt_pk_bf16_f32 v67, v54, v55
    v_cvt_pk_bf16_f32 v68, v56, v57
    buffer_store_dwordx4 v[64:67], v128, s[8:11], s78 offen sc1
    s_mov_b32 exec_hi, 0
    buffer_store_dword v68, v129, s[8:11], s79 offen sc1
    s_mov_b32 exec_hi, -1
    v_add_f32 v152, v152, v16
    v_add_f32 v153, v153, v17
    v_add_f32 v154, v154, v18
    v_add_f32 v155, v155, v19
    v_add_f32 v156, v156, v20
    v_add_f32 v157, v157, v21
    v_add_f32 v158, v158, v22
    v_add_f32 v159, v159, v23
    v_add_f32 v160, v160, v24
    v_add_f32 v161, v161, v25
    v_add_f32 v162, v162, v26
    v_mov_b32 v58, v162
    s_nop 1
    v_permlane32_swap_b32 v162, v58
    v_rcp_f32 v58, v162
    s_nop 0
    v_mul_f32 v58, v58, v14
    v_mul_f32 v48, v152, v58
    v_mul_f32 v49, v153, v58
    v_mul_f32 v50, v154, v58
    v_mul_f32 v51, v155, v58
    v_mul_f32 v52, v156, v58
    v_mul_f32 v53, v157, v58
    v_mul_f32 v54, v158, v58
    v_mul_f32 v55, v159, v58
    v_mul_f32 v56, v160, v58
    v_mul_f32 v57, v161, v58
    v_cvt_pk_bf16_f32 v72, v48, v49
    v_cvt_pk_bf16_f32 v73, v50, v51
    v_cvt_pk_bf16_f32 v74, v52, v53
    v_cvt_pk_bf16_f32 v75, v54, v55
    v_cvt_pk_bf16_f32 v76, v56, v57
    buffer_store_dwordx4 v[72:75], v128, s[8:11], s76 offen sc1
    s_mov_b32 exec_hi, 0
    buffer_store_dword v76, v129, s[8:11], s77 offen sc1
    s_mov_b32 exec_hi, -1
    v_add_f32 v2, |v136|, |v152|
    v_add_f32 v2, |v137|, v2
    v_add_f32 v2, |v153|, v2
    v_add_f32 v2, |v138|, v2
    v_add_f32 v2, |v154|, v2
    v_add_f32 v2, |v139|, v2
    v_add_f32 v2, |v155|, v2
    v_add_f32 v2, |v140|, v2
    v_add_f32 v2, |v156|, v2
    v_add_f32 v2, |v141|, v2
    v_add_f32 v2, |v157|, v2
    v_add_f32 v2, |v142|, v2
    v_add_f32 v2, |v158|, v2
    v_add_f32 v2, |v143|, v2
    v_add_f32 v2, |v159|, v2
    v_add_f32 v2, |v144|, v2
    v_add_f32 v2, |v160|, v2
    v_add_f32 v2, |v145|, v2
    v_add_f32 v2, |v161|, v2
    v_add_f32 v2, |v146|, v2
    v_add_f32 v2, |v162|, v2
    v_min_f32 v108, v146, v162
    v_mov_b32 v15, 0x7f800000
    v_cmp_le_f32 vcc, 201326592, v108
    v_cmp_lt_f32 s[6:7], v2, v15
    s_nop 0
    s_and_b64 vcc, vcc, s[6:7]
    s_cmp_eq_u64 vcc, exec
    s_cbranch_scc0 f_fallback
f_n2:
    s_waitcnt vmcnt(0)
    v_mov_b32 v2, 159804
    v_mov_b32 v14, 1
    s_mov_b64 exec, 1
    ds_add_rtn_u32 v14, v2, v14
    s_waitcnt lgkmcnt(0)
    v_readfirstlane_b32 s65, v14
    s_mov_b64 exec, -1
    s_cmp_lg_u32 s65, 3
    s_cbranch_scc1 f_a9
    s_lshl_b32 s65, s57, 7
    s_lshl_b32 s66, s58, 3
    s_add_u32 s65, s65, s66
    s_add_u32 s65, s65, 196608
    v_lshlrev_b32 v2, 12, v1
    v_mov_b32 v14, s54
    v_mov_b32 v15, s55
    s_mov_b64 exec, 15
    buffer_atomic_swap_x2 v[14:15], v2, s[8:11], s65 offen sc1
    s_mov_b64 exec, -1
f_a9:
    s_endpgm
f_fallback:
    s_waitcnt vmcnt(0)
    v_subrev_u32 v11, 70528, v11
    v_subrev_u32 v12, 70528, v12
    v_subrev_u32 v13, 70528, v13
    v_mov_b32 v105, 0
    v_mov_b32 v2, 0xff800000
    s_mov_b32 s59, 327680
f_fb10:
    buffer_load_dwordx4 v[96:99], v11, s[8:11], s59 offen sc1
    buffer_load_dword v104, v12, s[8:11], s59 offen sc1
    s_waitcnt vmcnt(0)
    v_mfma_f32_32x32x16_bf16 v[32:47], v[96:99], v[4:7], 0
    v_mfma_f32_32x32x8_bf16 v[32:47], v[104:105], v[8:9], v[32:47]
    s_nop 11
    v_max3_f32 v2, v32, v33, v2
    v_max3_f32 v2, v34, v35, v2
    v_max3_f32 v2, v36, v37, v2
    v_max3_f32 v2, v38, v39, v2
    v_max3_f32 v2, v40, v41, v2
    v_max3_f32 v2, v42, v43, v2
    v_max3_f32 v2, v44, v45, v2
    v_max3_f32 v2, v46, v47, v2
    s_add_u32 s59, s59, 2432
    s_cmp_lt_u32 s59, 483328
    s_cbranch_scc1 f_fb10
    v_mov_b32 v15, v2
    s_nop 1
    v_permlane32_swap_b32 v2, v15
    v_max_f32 v2, v2, v15
    v_cvt_pk_bf16_f32 v15, v2, v2
    v_and_b32 v15, 0xffff0000, v15
    v_sub_f32 v2, v2, v15
    v_cvt_pk_bf16_f32 v9, v15, v2
    v_cndmask_b32 v9, v9, 0, s[68:69]
    v_mov_b32 v105, 0xbf80bf80
    s_mov_b32 s59, 327680
    v_mov_b32 v136, 0
    v_mov_b32 v137, 0
    v_mov_b32 v138, 0
    v_mov_b32 v139, 0
    v_mov_b32 v140, 0
    v_mov_b32 v141, 0
    v_mov_b32 v142, 0
    v_mov_b32 v143, 0
    v_mov_b32 v144, 0
    v_mov_b32 v145, 0
    v_mov_b32 v146, 0
    v_mov_b32 v147, 0
    v_mov_b32 v148, 0
    v_mov_b32 v149, 0
    v_mov_b32 v150, 0
    v_mov_b32 v151, 0
f_fb20:
    buffer_load_dwordx4 v[96:99], v11, s[8:11], s59 offen sc1
    buffer_load_dword v104, v12, s[8:11], s59 offen sc1
    buffer_load_dwordx4 v[116:119], v13, s[8:11], s59 offen sc1
    buffer_load_dwordx4 v[120:123], v13, s[8:11], s59 offen offset:640 sc1
    s_waitcnt vmcnt(0)
    v_mfma_f32_32x32x16_bf16 v[32:47], v[96:99], v[4:7], 0
    v_mfma_f32_32x32x8_bf16 v[32:47], v[104:105], v[8:9], v[32:47]
    s_nop 11
    v_exp_f32 v32, v32
    v_exp_f32 v33, v33
    v_exp_f32 v34, v34
    v_exp_f32 v35, v35
    v_exp_f32 v36, v36
    v_exp_f32 v37, v37
    v_exp_f32 v38, v38
    v_exp_f32 v39, v39
    v_exp_f32 v40, v40
    v_exp_f32 v41, v41
    v_exp_f32 v42, v42
    v_exp_f32 v43, v43
    v_exp_f32 v44, v44
    v_exp_f32 v45, v45
    v_exp_f32 v46, v46
    v_exp_f32 v47, v47
    s_nop 1
    v_smfmac_f32_32x32x32_bf16 v[136:151], v[116:119], v[32:39], v3
    v_smfmac_f32_32x32x32_bf16 v[136:151], v[120:123], v[40:47], v3
    s_add_u32 s59, s59, 2432
    s_cmp_lt_u32 s59, 483328
    s_cbranch_scc1 f_fb20
    s_nop 11
    v_mov_b32 v58, v146
    s_nop 1
    v_permlane32_swap_b32 v146, v58
    v_rcp_f32 v58, v146
    s_nop 0
    v_mul_f32 v58, v58, v10
    v_mul_f32 v48, v136, v58
    v_mul_f32 v49, v137, v58
    v_mul_f32 v50, v138, v58
    v_mul_f32 v51, v139, v58
    v_mul_f32 v52, v140, v58
    v_mul_f32 v53, v141, v58
    v_mul_f32 v54, v142, v58
    v_mul_f32 v55, v143, v58
    v_mul_f32 v56, v144, v58
    v_mul_f32 v57, v145, v58
    v_cvt_pk_bf16_f32 v64, v48, v49
    v_cvt_pk_bf16_f32 v65, v50, v51
    v_cvt_pk_bf16_f32 v66, v52, v53
    v_cvt_pk_bf16_f32 v67, v54, v55
    v_cvt_pk_bf16_f32 v68, v56, v57
    buffer_store_dwordx4 v[64:67], v128, s[8:11], s78 offen sc1
    s_mov_b32 exec_hi, 0
    buffer_store_dword v68, v129, s[8:11], s79 offen sc1
    s_mov_b32 exec_hi, -1
    v_mov_b32 v107, 0
    v_mov_b32 v2, 0xff800000
    s_mov_b32 s59, 327680
f_fb11:
    buffer_load_dwordx4 v[100:103], v11, s[8:11], s59 offen sc1
    buffer_load_dword v106, v12, s[8:11], s59 offen sc1
    s_waitcnt vmcnt(0)
    v_mfma_f32_32x32x16_bf16 v[32:47], v[100:103], v[112:115], 0
    v_mfma_f32_32x32x8_bf16 v[32:47], v[106:107], v[110:111], v[32:47]
    s_nop 11
    v_max3_f32 v2, v32, v33, v2
    v_max3_f32 v2, v34, v35, v2
    v_max3_f32 v2, v36, v37, v2
    v_max3_f32 v2, v38, v39, v2
    v_max3_f32 v2, v40, v41, v2
    v_max3_f32 v2, v42, v43, v2
    v_max3_f32 v2, v44, v45, v2
    v_max3_f32 v2, v46, v47, v2
    s_add_u32 s59, s59, 2432
    s_cmp_lt_u32 s59, 483328
    s_cbranch_scc1 f_fb11
    v_mov_b32 v15, v2
    s_nop 1
    v_permlane32_swap_b32 v2, v15
    v_max_f32 v2, v2, v15
    v_cvt_pk_bf16_f32 v15, v2, v2
    v_and_b32 v15, 0xffff0000, v15
    v_sub_f32 v2, v2, v15
    v_cvt_pk_bf16_f32 v111, v15, v2
    v_cndmask_b32 v111, v111, 0, s[68:69]
    v_mov_b32 v107, 0xbf80bf80
    s_mov_b32 s59, 327680
    v_mov_b32 v152, 0
    v_mov_b32 v153, 0
    v_mov_b32 v154, 0
    v_mov_b32 v155, 0
    v_mov_b32 v156, 0
    v_mov_b32 v157, 0
    v_mov_b32 v158, 0
    v_mov_b32 v159, 0
    v_mov_b32 v160, 0
    v_mov_b32 v161, 0
    v_mov_b32 v162, 0
    v_mov_b32 v163, 0
    v_mov_b32 v164, 0
    v_mov_b32 v165, 0
    v_mov_b32 v166, 0
    v_mov_b32 v167, 0
f_fb21:
    buffer_load_dwordx4 v[100:103], v11, s[8:11], s59 offen sc1
    buffer_load_dword v106, v12, s[8:11], s59 offen sc1
    buffer_load_dwordx4 v[80:83], v13, s[8:11], s59 offen sc1
    buffer_load_dwordx4 v[84:87], v13, s[8:11], s59 offen offset:640 sc1
    s_waitcnt vmcnt(0)
    v_mfma_f32_32x32x16_bf16 v[32:47], v[100:103], v[112:115], 0
    v_mfma_f32_32x32x8_bf16 v[32:47], v[106:107], v[110:111], v[32:47]
    s_nop 11
    v_exp_f32 v32, v32
    v_exp_f32 v33, v33
    v_exp_f32 v34, v34
    v_exp_f32 v35, v35
    v_exp_f32 v36, v36
    v_exp_f32 v37, v37
    v_exp_f32 v38, v38
    v_exp_f32 v39, v39
    v_exp_f32 v40, v40
    v_exp_f32 v41, v41
    v_exp_f32 v42, v42
    v_exp_f32 v43, v43
    v_exp_f32 v44, v44
    v_exp_f32 v45, v45
    v_exp_f32 v46, v46
    v_exp_f32 v47, v47
    s_nop 1
    v_smfmac_f32_32x32x32_bf16 v[152:167], v[80:83], v[32:39], v3
    v_smfmac_f32_32x32x32_bf16 v[152:167], v[84:87], v[40:47], v3
    s_add_u32 s59, s59, 2432
    s_cmp_lt_u32 s59, 483328
    s_cbranch_scc1 f_fb21
    s_nop 11
    v_mov_b32 v58, v162
    s_nop 1
    v_permlane32_swap_b32 v162, v58
    v_rcp_f32 v58, v162
    s_nop 0
    v_mul_f32 v58, v58, v14
    v_mul_f32 v48, v152, v58
    v_mul_f32 v49, v153, v58
    v_mul_f32 v50, v154, v58
    v_mul_f32 v51, v155, v58
    v_mul_f32 v52, v156, v58
    v_mul_f32 v53, v157, v58
    v_mul_f32 v54, v158, v58
    v_mul_f32 v55, v159, v58
    v_mul_f32 v56, v160, v58
    v_mul_f32 v57, v161, v58
    v_cvt_pk_bf16_f32 v72, v48, v49
    v_cvt_pk_bf16_f32 v73, v50, v51
    v_cvt_pk_bf16_f32 v74, v52, v53
    v_cvt_pk_bf16_f32 v75, v54, v55
    v_cvt_pk_bf16_f32 v76, v56, v57
    buffer_store_dwordx4 v[72:75], v128, s[8:11], s76 offen sc1
    s_mov_b32 exec_hi, 0
    buffer_store_dword v76, v129, s[8:11], s77 offen sc1
    s_mov_b32 exec_hi, -1
    s_branch f_n2
f_end:
    s_endpgm
.p2align 8
.type rf_table,@object
rf_table:
.long 0x3f803f80,0x3f803f80,0x3f803f80,0x3f803f80,0x3f7b3f80,0x3f553f6d,0xbe48248d,0xbf0ebec4
.long 0x3f6d3f80,0x3ec43f35,0xbf6dbf80,0xbec4bf35,0x3f553f80,0xbe483ec4,0x3f0ea554,0x3f7b3f6d
.long 0x3f353f80,0xbf35248d,0x3f353f80,0xbf35248d,0x3f0e3f80,0xbf7bbec4,0xbf55248d,0xbe48bf6d
.long 0x3ec43f80,0xbf6dbf35,0xbec4bf80,0x3f6d3f35,0x3e483f80,0xbf0ebf6d,0x3f7ba554,0xbf553ec4
.long 0x248d3f80,0xa554bf80,0x248d3f80,0xa554bf80,0xbe483f80,0x3f0ebf6d,0xbf7b248d,0x3f553ec4
.long 0xbec43f80,0x3f6dbf35,0x3ec4bf80,0xbf6d3f35,0xbf0e3f80,0x3f7bbec4,0x3f55a554,0x3e48bf6d
.long 0xbf353f80,0x3f35a554,0xbf353f80,0x3f35a554,0xbf553f80,0x3e483ec4,0xbf0e248d,0xbf7b3f6d
.long 0xbf6d3f80,0xbec43f35,0x3f6dbf80,0x3ec4bf35,0xbf7b3f80,0xbf553f6d,0x3e48a554,0x3f0ebec4
.long 0xbf803f80,0xbf803f80,0xbf803f80,0xbf803f80,0xbf7b3f80,0xbf553f6d,0x3e48248d,0x3f0ebec4
.long 0xbf6d3f80,0xbec43f35,0x3f6dbf80,0x3ec4bf35,0xbf553f80,0x3e483ec4,0xbf0ea554,0xbf7b3f6d
.long 0xbf353f80,0x3f35248d,0xbf353f80,0x3f35248d,0xbf0e3f80,0x3f7bbec4,0x3f55248d,0x3e48bf6d
.long 0xbec43f80,0x3f6dbf35,0x3ec4bf80,0xbf6d3f35,0xbe483f80,0x3f0ebf6d,0xbf7ba554,0x3f553ec4
.long 0xa5543f80,0x248dbf80,0xa5543f80,0x248dbf80,0x3e483f80,0xbf0ebf6d,0x3f7b248d,0xbf553ec4
.long 0x3ec43f80,0xbf6dbf35,0xbec4bf80,0x3f6d3f35,0x3f0e3f80,0xbf7bbec4,0xbf55a554,0xbe48bf6d
.long 0x3f353f80,0xbf35a554,0x3f353f80,0xbf35a554,0x3f553f80,0xbe483ec4,0x3f0e248d,0x3f7b3f6d
.long 0x3f6d3f80,0x3ec43f35,0xbf6dbf80,0xbec4bf35,0x3f7b3f80,0x3f553f6d,0xbe48a554,0xbf0ebec4
.long 0x3f803f80,0x3f803f80,0x3f803f80,0x3f803f80,0x3f0e3f35,0x3e483ec4,0xbf55bf35,0xbf7bbf6d
.long 0xbec4248d,0xbf6dbf35,0x3ec4a554,0x3f6d3f35,0xbf7bbf35,0xbf0ebf6d,0x3e483f35,0xbf55bec4
.long 0xbf35bf80,0x3f35a554,0xbf35bf80,0x3f35a554,0x3e48bf35,0x3f553f6d,0x3f7b3f35,0xbf0e3ec4
.long 0x3f6da554,0xbec43f35,0xbf6d248d,0x3ec4bf35,0x3f553f35,0xbf7bbec4,0x3f0ebf35,0xbe483f6d
.long 0x248d3f80,0xa554bf80,0x248d3f80,0xa554bf80,0xbf553f35,0x3f7bbec4,0xbf0ebf35,0x3e483f6d
.long 0xbf6d248d,0x3ec43f35,0x3f6da554,0xbec4bf35,0xbe48bf35,0xbf553f6d,0xbf7b3f35,0x3f0e3ec4
.long 0x3f35bf80,0xbf35248d,0x3f35bf80,0xbf35248d,0x3f7bbf35,0x3f0ebf6d,0xbe483f35,0x3f55bec4
.long 0x3ec4a554,0x3f6dbf35,0xbec4248d,0xbf6d3f35,0xbf0e3f35,0xbe483ec4,0x3f55bf35,0x3f7bbf6d
.long 0xbf803f80,0xbf803f80,0xbf803f80,0xbf803f80,0xbf0e3f35,0xbe483ec4,0x3f55bf35,0x3f7bbf6d
.long 0x3ec4248d,0x3f6dbf35,0xbec4a554,0xbf6d3f35,0x3f7bbf35,0x3f0ebf6d,0xbe483f35,0x3f55bec4
.long 0x3f35bf80,0xbf35a554,0x3f35bf80,0xbf35a554,0xbe48bf35,0xbf553f6d,0xbf7b3f35,0x3f0e3ec4
.long 0xbf6da554,0x3ec43f35,0x3f6d248d,0xbec4bf35,0xbf553f35,0x3f7bbec4,0xbf0ebf35,0x3e483f6d
.long 0xa5543f80,0x248dbf80,0xa5543f80,0x248dbf80,0x3f553f35,0xbf7bbec4,0x3f0ebf35,0xbe483f6d
.long 0x3f6d248d,0xbec43f35,0xbf6da554,0x3ec4bf35,0x3e48bf35,0x3f553f6d,0x3f7b3f35,0xbf0e3ec4
.long 0xbf35bf80,0x3f35248d,0xbf35bf80,0x3f35248d,0xbf7bbf35,0xbf0ebf6d,0x3e483f35,0xbf55bec4
.long 0xbec4a554,0xbf6dbf35,0x3ec4248d,0x3f6d3f35,0x3f0e3f35,0x3e483ec4,0xbf55bf35,0xbf7bbf6d
.long 0x3f803f80,0x3f803f80,0x3f803f80,0x3f803f80,0xbf7bbf80,0xbf55bf6d,0x3e48a554,0x3f0e3ec4
.long 0x3f6d3f80,0x3ec43f35,0xbf6dbf80,0xbec4bf35,0xbf55bf80,0x3e48bec4,0xbf0e248d,0xbf7bbf6d
.long 0x3f353f80,0xbf35248d,0x3f353f80,0xbf35248d,0xbf0ebf80,0x3f7b3ec4,0x3f55a554,0x3e483f6d
.long 0x3ec43f80,0xbf6dbf35,0xbec4bf80,0x3f6d3f35,0xbe48bf80,0x3f0e3f6d,0xbf7b248d,0x3f55bec4
.long 0x248d3f80,0xa554bf80,0x248d3f80,0xa554bf80,0x3e48bf80,0xbf0e3f6d,0x3f7ba554,0xbf55bec4
.long 0xbec43f80,0x3f6dbf35,0x3ec4bf80,0xbf6d3f35,0x3f0ebf80,0xbf7b3ec4,0xbf55248d,0xbe483f6d
.long 0xbf353f80,0x3f35a554,0xbf353f80,0x3f35a554,0x3f55bf80,0xbe48bec4,0x3f0ea554,0x3f7bbf6d
.long 0xbf6d3f80,0xbec43f35,0x3f6dbf80,0x3ec4bf35,0x3f7bbf80,0x3f55bf6d,0xbe48248d,0xbf0e3ec4
.long 0xbf803f80,0xbf803f80,0xbf803f80,0xbf803f80,0x3f7bbf80,0x3f55bf6d,0xbe48a554,0xbf0e3ec4
.long 0xbf6d3f80,0xbec43f35,0x3f6dbf80,0x3ec4bf35,0x3f55bf80,0xbe48bec4,0x3f0e248d,0x3f7bbf6d
.long 0xbf353f80,0x3f35248d,0xbf353f80,0x3f35248d,0x3f0ebf80,0xbf7b3ec4,0xbf55a554,0xbe483f6d
.long 0xbec43f80,0x3f6dbf35,0x3ec4bf80,0xbf6d3f35,0x3e48bf80,0xbf0e3f6d,0x3f7b248d,0xbf55bec4
.long 0xa5543f80,0x248dbf80,0xa5543f80,0x248dbf80,0xbe48bf80,0x3f0e3f6d,0xbf7ba554,0x3f55bec4
.long 0x3ec43f80,0xbf6dbf35,0xbec4bf80,0x3f6d3f35,0xbf0ebf80,0x3f7b3ec4,0x3f55248d,0x3e483f6d
.long 0x3f353f80,0xbf35a554,0x3f353f80,0xbf35a554,0xbf55bf80,0x3e48bec4,0xbf0ea554,0xbf7bbf6d
.long 0x3f6d3f80,0x3ec43f35,0xbf6dbf80,0xbec4bf35,0xbf7bbf80,0xbf55bf6d,0x3e48248d,0x3f0e3ec4
.long 0x3f803f80,0x3f803f80,0x3f803f80,0x3f803f80,0xbf0ebf35,0xbe48bec4,0x3f553f35,0x3f7b3f6d
.long 0xbec4248d,0xbf6dbf35,0x3ec4a554,0x3f6d3f35,0x3f7b3f35,0x3f0e3f6d,0xbe48bf35,0x3f553ec4
.long 0xbf35bf80,0x3f35a554,0xbf35bf80,0x3f35a554,0xbe483f35,0xbf55bf6d,0xbf7bbf35,0x3f0ebec4
.long 0x3f6da554,0xbec43f35,0xbf6d248d,0x3ec4bf35,0xbf55bf35,0x3f7b3ec4,0xbf0e3f35,0x3e48bf6d
.long 0x248d3f80,0xa554bf80,0x248d3f80,0xa554bf80,0x3f55bf35,0xbf7b3ec4,0x3f0e3f35,0xbe48bf6d
.long 0xbf6d248d,0x3ec43f35,0x3f6da554,0xbec4bf35,0x3e483f35,0x3f55bf6d,0x3f7bbf35,0xbf0ebec4
.long 0x3f35bf80,0xbf35248d,0x3f35bf80,0xbf35248d,0xbf7b3f35,0xbf0e3f6d,0x3e48bf35,0xbf553ec4
.long 0x3ec4a554,0x3f6dbf35,0xbec4248d,0xbf6d3f35,0x3f0ebf35,0x3e48bec4,0xbf553f35,0xbf7b3f6d
.long 0xbf803f80,0xbf803f80,0xbf803f80,0xbf803f80,0x3f0ebf35,0x3e48bec4,0xbf553f35,0xbf7b3f6d
.long 0x3ec4248d,0x3f6dbf35,0xbec4a554,0xbf6d3f35,0xbf7b3f35,0xbf0e3f6d,0x3e48bf35,0xbf553ec4
.long 0x3f35bf80,0xbf35a554,0x3f35bf80,0xbf35a554,0x3e483f35,0x3f55bf6d,0x3f7bbf35,0xbf0ebec4
.long 0xbf6da554,0x3ec43f35,0x3f6d248d,0xbec4bf35,0x3f55bf35,0xbf7b3ec4,0x3f0e3f35,0xbe48bf6d
.long 0xa5543f80,0x248dbf80,0xa5543f80,0x248dbf80,0xbf55bf35,0x3f7b3ec4,0xbf0e3f35,0x3e48bf6d
.long 0x3f6d248d,0xbec43f35,0xbf6da554,0x3ec4bf35,0xbe483f35,0xbf55bf6d,0xbf7bbf35,0x3f0ebec4
.long 0xbf35bf80,0x3f35248d,0xbf35bf80,0x3f35248d,0x3f7b3f35,0x3f0e3f6d,0xbe48bf35,0x3f553ec4
.long 0xbec4a554,0xbf6dbf35,0x3ec4248d,0x3f6d3f35,0xbf0ebf35,0xbe48bec4,0x3f553f35,0x3f7b3f6d
.long 0x00000000,0x00000000,0x00000000,0x00000000,0x3e480000,0x3f0e3ec4,0x3f7b3f80,0x3f553f6d
.long 0x3ec40000,0x3f6d3f35,0xbec4250d,0xbf6dbf35,0x3f0e0000,0x3f7b3f6d,0xbf55bf80,0x3e48bec4
.long 0x3f350000,0x3f353f80,0x3f350000,0x3f353f80,0x3f550000,0x3e483f6d,0x3f0e3f80,0xbf7bbec4
.long 0x3f6d0000,0xbec43f35,0xbf6d250d,0x3ec4bf35,0x3f7b0000,0xbf553ec4,0xbe48bf80,0x3f0e3f6d
.long 0x3f800000,0xbf80250d,0x3f800000,0xbf80250d,0x3f7b0000,0xbf55bec4,0xbe483f80,0x3f0ebf6d
.long 0x3f6d0000,0xbec4bf35,0xbf6d250d,0x3ec43f35,0x3f550000,0x3e48bf6d,0x3f0ebf80,0xbf7b3ec4
.long 0x3f350000,0x3f35bf80,0x3f350000,0x3f35bf80,0x3f0e0000,0x3f7bbf6d,0xbf553f80,0x3e483ec4
.long 0x3ec40000,0x3f6dbf35,0xbec4250d,0xbf6d3f35,0x3e480000,0x3f0ebec4,0x3f7bbf80,0x3f55bf6d
.long 0x250d0000,0x250d0000,0x250d0000,0x250d0000,0xbe480000,0xbf0e3ec4,0xbf7b3f80,0xbf553f6d
.long 0xbec40000,0xbf6d3f35,0x3ec4250d,0x3f6dbf35,0xbf0e0000,0xbf7b3f6d,0x3f55bf80,0xbe48bec4
.long 0xbf350000,0xbf353f80,0xbf350000,0xbf353f80,0xbf550000,0xbe483f6d,0xbf0e3f80,0x3f7bbec4
.long 0xbf6d0000,0x3ec43f35,0x3f6d250d,0xbec4bf35,0xbf7b0000,0x3f553ec4,0x3e48bf80,0xbf0e3f6d
.long 0xbf800000,0x3f80250d,0xbf800000,0x3f80250d,0xbf7b0000,0x3f55bec4,0x3e483f80,0xbf0ebf6d
.long 0xbf6d0000,0x3ec4bf35,0x3f6d250d,0xbec43f35,0xbf550000,0xbe48bf6d,0xbf0ebf80,0x3f7b3ec4
.long 0xbf350000,0xbf35bf80,0xbf350000,0xbf35bf80,0xbf0e0000,0xbf7bbf6d,0x3f553f80,0xbe483ec4
.long 0xbec40000,0xbf6dbf35,0x3ec4250d,0x3f6d3f35,0xbe480000,0xbf0ebec4,0xbf7bbf80,0xbf55bf6d
.long 0x00000000,0x00000000,0x00000000,0x00000000,0x3f553f35,0x3f7b3f6d,0x3f0e3f35,0x3e483ec4
.long 0x3f6d3f80,0x3ec43f35,0xbf6dbf80,0xbec4bf35,0x3e483f35,0xbf55bec4,0x3f7b3f35,0x3f0e3f6d
.long 0xbf35250d,0xbf35bf80,0xbf35250d,0xbf35bf80,0xbf7bbf35,0x3f0ebec4,0x3e48bf35,0x3f553f6d
.long 0xbec4bf80,0x3f6d3f35,0x3ec43f80,0xbf6dbf35,0x3f0ebf35,0xbe483f6d,0xbf55bf35,0x3f7b3ec4
.long 0x3f800000,0xbf80250d,0x3f800000,0xbf80250d,0x3f0e3f35,0xbe48bf6d,0xbf553f35,0x3f7bbec4
.long 0xbec43f80,0x3f6dbf35,0x3ec4bf80,0xbf6d3f35,0xbf7b3f35,0x3f0e3ec4,0x3e483f35,0x3f55bf6d
.long 0xbf35250d,0xbf353f80,0xbf35250d,0xbf353f80,0x3e48bf35,0xbf553ec4,0x3f7bbf35,0x3f0ebf6d
.long 0x3f6dbf80,0x3ec4bf35,0xbf6d3f80,0xbec43f35,0x3f55bf35,0x3f7bbf6d,0x3f0ebf35,0x3e48bec4
.long 0x250d0000,0x250d0000,0x250d0000,0x250d0000,0xbf553f35,0xbf7b3f6d,0xbf0e3f35,0xbe483ec4
.long 0xbf6d3f80,0xbec43f35,0x3f6dbf80,0x3ec4bf35,0xbe483f35,0x3f55bec4,0xbf7b3f35,0xbf0e3f6d
.long 0x3f35250d,0x3f35bf80,0x3f35250d,0x3f35bf80,0x3f7bbf35,0xbf0ebec4,0xbe48bf35,0xbf553f6d
.long 0x3ec4bf80,0xbf6d3f35,0xbec43f80,0x3f6dbf35,0xbf0ebf35,0x3e483f6d,0x3f55bf35,0xbf7b3ec4
.long 0xbf800000,0x3f80250d,0xbf800000,0x3f80250d,0xbf0e3f35,0x3e48bf6d,0x3f553f35,0xbf7bbec4
.long 0x3ec43f80,0xbf6dbf35,0xbec4bf80,0x3f6d3f35,0x3f7b3f35,0xbf0e3ec4,0xbe483f35,0xbf55bf6d
.long 0x3f35250d,0x3f353f80,0x3f35250d,0x3f353f80,0xbe48bf35,0x3f553ec4,0xbf7bbf35,0xbf0ebf6d
.long 0xbf6dbf80,0xbec4bf35,0x3f6d3f80,0x3ec43f35,0xbf55bf35,0xbf7bbf6d,0xbf0ebf35,0xbe48bec4
.long 0x00000000,0x00000000,0x00000000,0x00000000,0xbe48250d,0xbf0ebec4,0xbf7bbf80,0xbf55bf6d
.long 0x3ec40000,0x3f6d3f35,0xbec4250d,0xbf6dbf35,0xbf0e250d,0xbf7bbf6d,0x3f553f80,0xbe483ec4
.long 0x3f350000,0x3f353f80,0x3f350000,0x3f353f80,0xbf55250d,0xbe48bf6d,0xbf0ebf80,0x3f7b3ec4
.long 0x3f6d0000,0xbec43f35,0xbf6d250d,0x3ec4bf35,0xbf7b250d,0x3f55bec4,0x3e483f80,0xbf0ebf6d
.long 0x3f800000,0xbf80250d,0x3f800000,0xbf80250d,0xbf7b250d,0x3f553ec4,0x3e48bf80,0xbf0e3f6d
.long 0x3f6d0000,0xbec4bf35,0xbf6d250d,0x3ec43f35,0xbf55250d,0xbe483f6d,0xbf0e3f80,0x3f7bbec4
.long 0x3f350000,0x3f35bf80,0x3f350000,0x3f35bf80,0xbf0e250d,0xbf7b3f6d,0x3f55bf80,0xbe48bec4
.long 0x3ec40000,0x3f6dbf35,0xbec4250d,0xbf6d3f35,0xbe48250d,0xbf0e3ec4,0xbf7b3f80,0xbf553f6d
.long 0x250d0000,0x250d0000,0x250d0000,0x250d0000,0x3e48250d,0x3f0ebec4,0x3f7bbf80,0x3f55bf6d
.long 0xbec40000,0xbf6d3f35,0x3ec4250d,0x3f6dbf35,0x3f0e250d,0x3f7bbf6d,0xbf553f80,0x3e483ec4
.long 0xbf350000,0xbf353f80,0xbf350000,0xbf353f80,0x3f55250d,0x3e48bf6d,0x3f0ebf80,0xbf7b3ec4
.long 0xbf6d0000,0x3ec43f35,0x3f6d250d,0xbec4bf35,0x3f7b250d,0xbf55bec4,0xbe483f80,0x3f0ebf6d
.long 0xbf800000,0x3f80250d,0xbf800000,0x3f80250d,0x3f7b250d,0xbf553ec4,0xbe48bf80,0x3f0e3f6d
.long 0xbf6d0000,0x3ec4bf35,0x3f6d250d,0xbec43f35,0x3f55250d,0x3e483f6d,0x3f0e3f80,0xbf7bbec4
.long 0xbf350000,0xbf35bf80,0xbf350000,0xbf35bf80,0x3f0e250d,0x3f7b3f6d,0xbf55bf80,0x3e48bec4
.long 0xbec40000,0xbf6dbf35,0x3ec4250d,0x3f6d3f35,0x3e48250d,0x3f0e3ec4,0x3f7b3f80,0x3f553f6d
.long 0x00000000,0x00000000,0x00000000,0x00000000,0xbf55bf35,0xbf7bbf6d,0xbf0ebf35,0xbe48bec4
.long 0x3f6d3f80,0x3ec43f35,0xbf6dbf80,0xbec4bf35,0xbe48bf35,0x3f553ec4,0xbf7bbf35,0xbf0ebf6d
.long 0xbf35250d,0xbf35bf80,0xbf35250d,0xbf35bf80,0x3f7b3f35,0xbf0e3ec4,0xbe483f35,0xbf55bf6d
.long 0xbec4bf80,0x3f6d3f35,0x3ec43f80,0xbf6dbf35,0xbf0e3f35,0x3e48bf6d,0x3f553f35,0xbf7bbec4
.long 0x3f800000,0xbf80250d,0x3f800000,0xbf80250d,0xbf0ebf35,0x3e483f6d,0x3f55bf35,0xbf7b3ec4
.long 0xbec43f80,0x3f6dbf35,0x3ec4bf80,0xbf6d3f35,0x3f7bbf35,0xbf0ebec4,0xbe48bf35,0xbf553f6d
.long 0xbf35250d,0xbf353f80,0xbf35250d,0xbf353f80,0xbe483f35,0x3f55bec4,0xbf7b3f35,0xbf0e3f6d
.long 0x3f6dbf80,0x3ec4bf35,0xbf6d3f80,0xbec43f35,0xbf553f35,0xbf7b3f6d,0xbf0e3f35,0xbe483ec4
.long 0x250d0000,0x250d0000,0x250d0000,0x250d0000,0x3f55bf35,0x3f7bbf6d,0x3f0ebf35,0x3e48bec4
.long 0xbf6d3f80,0xbec43f35,0x3f6dbf80,0x3ec4bf35,0x3e48bf35,0xbf553ec4,0x3f7bbf35,0x3f0ebf6d
.long 0x3f35250d,0x3f35bf80,0x3f35250d,0x3f35bf80,0xbf7b3f35,0x3f0e3ec4,0x3e483f35,0x3f55bf6d
.long 0x3ec4bf80,0xbf6d3f35,0xbec43f80,0x3f6dbf35,0x3f0e3f35,0xbe48bf6d,0xbf553f35,0x3f7bbec4
.long 0xbf800000,0x3f80250d,0xbf800000,0x3f80250d,0x3f0ebf35,0xbe483f6d,0xbf55bf35,0x3f7b3ec4
.long 0x3ec43f80,0xbf6dbf35,0xbec4bf80,0x3f6d3f35,0xbf7bbf35,0x3f0ebec4,0x3e48bf35,0x3f553f6d
.long 0x3f35250d,0x3f353f80,0x3f35250d,0x3f353f80,0x3e483f35,0xbf55bec4,0x3f7b3f35,0x3f0e3f6d
.long 0xbf6dbf80,0xbec4bf35,0x3f6d3f80,0x3ec43f35,0x3f553f35,0x3f7b3f6d,0x3f0e3f35,0x3e483ec4
.size rf_table, 4096
rf_end:
.section .rodata,"a"
.p2align 6
.amdhsa_kernel gated_mix__spectral_fnet__grouped_kv_mqa__prompt_kernel
  .amdhsa_next_free_vgpr 168
  .amdhsa_next_free_sgpr 102
  .amdhsa_accum_offset 168
  .amdhsa_group_segment_fixed_size 0
  .amdhsa_kernarg_size 112
  .amdhsa_user_sgpr_count 2
  .amdhsa_user_sgpr_kernarg_segment_ptr 1
  .amdhsa_system_sgpr_workgroup_id_x 1
.end_amdhsa_kernel
```
